```python
import torch

def _softmax(x, axis=-1):
    return torch.softmax(x, dim=axis)
def _gelu(x):
    return torch.nn.functional.gelu(x, approximate="tanh")
def _silu(x):
    return torch.nn.functional.silu(x)
def _sigmoid(x):
    return torch.sigmoid(x)
def _layernorm(x, axis=-1, eps=1e-5):
    m = x.mean(dim=axis, keepdim=True)
    v = x.var(dim=axis, keepdim=True, unbiased=False)
    return (x - m) / torch.sqrt(v + eps)
def _scatter_add(tgt, idx, src, axis=0):
    return tgt.clone().index_add_(axis, idx, src)
def _segment_sum(src, seg, n):
    out = torch.zeros((n,) + src.shape[1:], dtype=src.dtype)
    return out.index_add_(0, seg, src)
def _pad(x, pw):
    flat = tuple(v for pair in reversed(pw) for v in pair)
    return torch.nn.functional.pad(x, flat)

kernel_name = 'standalone__deep_cross_pnn__recsys'

def setup_inputs():

    _w = (lambda a: (lambda t: t.to(torch.bfloat16) if t.is_floating_point() else t)(torch.as_tensor(a)))
    B, F, D, V = 16384, 100, 32, min(1000000, 100000)
    H = 4 * D
    return {
        "idx": _w((lambda lo, hi, *s: torch.randint(lo, hi, s))(0, V, B, F).to(torch.int64)),
        "table": _w((lambda *s: torch.randn(*s, dtype=torch.bfloat16) * 1.6)(V, D) * (D ** -0.5)),
        "w_p": _w((lambda *s: torch.randn(*s, dtype=torch.bfloat16) * 0.05)(F * F) * ((F * F) ** -0.5)),
        "w1": _w((lambda *s: torch.randn(*s, dtype=torch.bfloat16) * 1.6)(F * D, H) * ((F * D) ** -0.5)),
        "b1": _w((lambda *s: torch.randn(*s, dtype=torch.bfloat16) * 1.6)(H) * 0.01),
        "w2": _w((lambda *s: torch.randn(*s, dtype=torch.bfloat16) * 0.05)(H) * (H ** -0.5)),
        "b2": _w((lambda *s: torch.randn(*s, dtype=torch.bfloat16) * 0.05)(1) * 0.01),
    }

def reference(idx, table, w_p, w1, b1, w2, b2):
    emb = table[idx]
    B = emb.shape[0]; F = emb.shape[1]; D = emb.shape[2]
    ip = torch.einsum('bid,bjd->bij', emb, emb)
    ip = ip.reshape(B, F * F)
    logit_p = ip @ w_p
    z = emb.reshape(B, F * D)
    h = _gelu(z @ w1 + b1)
    logit_d = h @ w2 + b2
    return logit_p + logit_d
```

```asm
; @launch grid=(256,1,1) block=(256,1,1) lds=163840
.amdgcn_target "amdgcn-amd-amdhsa--gfx950"
.text
.globl standalone__deep_cross_pnn__recsys_kernel
.p2align 8
.type standalone__deep_cross_pnn__recsys_kernel,@function
standalone__deep_cross_pnn__recsys_kernel:
    s_cmp_ge_u32 s2, 256
    s_cbranch_scc1 L_end
    s_load_dwordx16 s[4:19], s[0:1], 0
    v_lshrrev_b32 v45, 6, v0
    v_and_b32 v44, 63, v0
    v_readfirstlane_b32 s52, v45
    v_lshrrev_b32 v46, 2, v44
    v_and_b32 v47, 3, v44
    v_mul_u32_u24 v54, 400, v46
    v_lshl_add_u32 v54, v47, 4, v54
    s_mul_i32 s53, s2, 25600
    s_mul_i32 s57, s52, 6400
    s_add_u32 s53, s53, s57
    s_mov_b32 s22, 6553600
    s_mov_b32 s23, 0x00020000
    s_mov_b32 s30, 819200
    s_mov_b32 s31, 0x00020000
    s_lshl_b32 s54, s52, 10
    s_lshl_b32 s55, s52, 11
    s_add_u32 s55, s55, 99072
    v_lshrrev_b32 v11, 4, v44
    v_and_b32 v48, 3, v46
    v_lshlrev_b32 v12, 4, v44
    v_xor_b32 v5, v48, v11
    v_lshlrev_b32 v5, 6, v5
    v_lshl_add_u32 v5, v11, 8, v5
    v_and_b32 v17, 1, v45
    v_lshlrev_b32 v17, 1, v17
    v_xor_b32 v17, v17, v47
    v_lshl_add_u32 v5, v17, 4, v5
    v_lshl_add_u32 v5, v45, 11, v5
    s_waitcnt lgkmcnt(0)
    s_mov_b32 s20, s4
    s_and_b32 s21, s5, 0xffff
    buffer_load_dwordx4 v[212:215], v54, s[20:23], s53 offen offset:384
    buffer_load_dwordx4 v[192:195], v54, s[20:23], s53 offen offset:0
    s_mov_b32 s28, s10
    s_and_b32 s29, s11, 0xffff
    s_add_u32 m0, s55, 0
    s_mov_b32 s56, 786432
    buffer_load_dwordx4 v5, s[28:31], s56 offen  lds
    buffer_load_dwordx4 v5, s[28:31], s56 offen offset:1024  lds
    s_add_u32 m0, s55, 8192
    s_mov_b32 s56, 794624
    buffer_load_dwordx4 v5, s[28:31], s56 offen  lds
    buffer_load_dwordx4 v5, s[28:31], s56 offen offset:1024  lds
    s_mov_b32 s24, s6
    s_and_b32 s25, s7, 0xffff
    s_mov_b32 s26, 6400000
    s_mov_b32 s27, 0x00020000
    s_mov_b32 s32, s8
    s_and_b32 s33, s9, 0xffff
    s_mov_b32 s34, 20000
    s_mov_b32 s35, 0x00020000
    s_mov_b32 s36, s12
    s_and_b32 s37, s13, 0xffff
    s_mov_b32 s38, 256
    s_mov_b32 s39, 0x00020000
    s_mov_b32 s40, s14
    s_and_b32 s41, s15, 0xffff
    s_mov_b32 s42, 256
    s_mov_b32 s43, 0x00020000
    s_mov_b32 s44, s18
    s_and_b32 s45, s19, 0xffff
    s_mov_b32 s46, 32768
    s_mov_b32 s47, 0x00020000
    v_min_u32 v56, 3, v44
    v_lshlrev_b32 v56, 21, v56
    s_lshl_b32 s57, s2, 7
    buffer_load_dword a197, v56, s[24:27], s57 offen
    s_mul_i32 s57, s52, 5120
    s_add_u32 m0, s57, 78432
    s_load_dword s58, s[16:17], 0
    buffer_load_dwordx4 v12, s[32:35], s57 offen offset:0  lds
    buffer_load_dwordx4 v12, s[32:35], s57 offen offset:1024  lds
    buffer_load_dwordx4 v12, s[32:35], s57 offen offset:2048  lds
    buffer_load_dwordx4 v12, s[32:35], s57 offen offset:3072  lds
    s_add_u32 s57, s57, 4096
    s_add_u32 m0, m0, 4096
    v_lshlrev_b32 v56, 3, v11
    buffer_load_dwordx4 v12, s[32:35], s57 offen  lds
    v_lshl_add_u32 v56, v45, 6, v56
    buffer_load_dwordx2 v[92:93], v56, s[36:39], 0 offen offset:0
    buffer_load_dwordx2 v[94:95], v56, s[36:39], 0 offen offset:32
    s_mov_b32 m0, 163440
    v_lshlrev_b32 v56, 2, v44
    buffer_load_dword v56, s[40:43], 0 offen lds
    s_mul_i32 s57, s2, 3200
    s_mul_i32 s59, s52, 800
    s_add_u32 s57, s57, s59
    buffer_load_dwordx4 a[192:195], v12, s[28:31], s57 offen
    s_lshr_b32 s57, s2, 3
    s_and_b32 s57, s57, 31
    s_lshl_b32 s57, s57, 2
    s_add_u32 s57, s57, s52
    s_mul_i32 s57, s57, 384
    v_min_u32 v56, 2, v44
    v_lshlrev_b32 v56, 7, v56
    v_add_u32 v56, s57, v56
    v_min_u32 v56, L_end-L_pc-128, v56
    s_lshr_b32 s57, s2, 1
    s_and_b32 s57, s57, 28
    s_add_u32 s57, s57, s52
    s_lshl_b32 s57, s57, 7
    v_mov_b32 v189, s57
    s_getpc_b64 s[62:63]
L_pc:
    global_load_dword a196, v56, s[62:63]
    v_sub_u32 v18, 0, v11
    v_and_b32 v18, 3, v18
    v_xor_b32 v6, v47, v18
    v_lshlrev_b32 v6, 4, v6
    v_sub_u32 v18, 0, v48
    v_and_b32 v18, 3, v18
    v_xor_b32 v4, v48, v45
    v_lshlrev_b32 v4, 6, v4
    v_lshl_add_u32 v4, v48, 8, v4
    v_lshl_add_u32 v4, v47, 3, v4
    v_and_b32 v17, 1, v11
    v_lshl_add_u32 v4, v17, 5, v4
    v_lshl_add_u32 v4, v11, 11, v4
    v_add_u32 v4, 99072, v4
    v_xor_b32 v2, 32, v4
    v_xor_b32 v17, v11, v18
    v_and_b32 v0, 15, v44
    v_lshlrev_b32 v0, 6, v0
    v_lshl_add_u32 v0, v17, 4, v0
    v_add_u32 v1, 49536, v0
    v_mul_u32_u24 v55, 4128, v48
    v_lshl_add_u32 v55, v45, 10, v55
    v_lshl_add_u32 v55, v47, 8, v55
    v_sub_u32 v18, 0, v47
    v_and_b32 v18, 3, v18
    v_xor_b32 v17, v18, v11
    v_lshl_add_u32 v55, v17, 4, v55
    v_and_b32 v17, 15, v44
    v_mul_u32_u24 v8, 4128, v17
    v_lshl_add_u32 v8, v45, 10, v8
    v_mul_u32_u24 v49, 200, v17
    v_lshl_add_u32 v49, v11, 3, v49
    v_add_u32 v49, 78432, v49
    v_lshlrev_b32 v17, 4, v17
    v_lshl_add_u32 v17, v11, 2, v17
    v_add_u32 v13, 161536, v17
    v_mul_u32_u24 v50, 200, v46
    v_lshl_add_u32 v50, v47, 3, v50
    v_add_u32 v50, 78432, v50
    v_add_u32 v51, 140032, v12
    s_waitcnt vmcnt(16)
    v_lshlrev_b32 v212, 6, v212
    v_lshlrev_b32 v213, 6, v213
    v_lshlrev_b32 v214, 6, v214
    v_lshlrev_b32 v215, 6, v215
    s_waitcnt vmcnt(15)
    v_lshlrev_b32 v192, 6, v192
    v_lshlrev_b32 v193, 6, v193
    v_lshlrev_b32 v194, 6, v194
    v_lshlrev_b32 v195, 6, v195
    s_add_u32 m0, s54, 0
    v_add_u32_dpp v7, v212, v6 quad_perm:[0,0,0,0] row_mask:0xf bank_mask:0xf
    buffer_load_dwordx4 v7, s[24:27], 0 offen  lds
    s_add_u32 m0, s54, 4128
    v_add_u32_dpp v7, v213, v6 quad_perm:[0,0,0,0] row_mask:0xf bank_mask:0xf
    buffer_load_dwordx4 v7, s[24:27], 0 offen  lds
    s_add_u32 m0, s55, 16384
    s_mov_b32 s56, 802816
    buffer_load_dwordx4 v5, s[28:31], s56 offen  lds
    buffer_load_dwordx4 v5, s[28:31], s56 offen offset:1024  lds
    s_add_u32 m0, s54, 8256
    v_add_u32_dpp v7, v214, v6 quad_perm:[0,0,0,0] row_mask:0xf bank_mask:0xf
    buffer_load_dwordx4 v7, s[24:27], 0 offen  lds
    s_add_u32 m0, s54, 12384
    v_add_u32_dpp v7, v215, v6 quad_perm:[0,0,0,0] row_mask:0xf bank_mask:0xf
    buffer_load_dwordx4 v7, s[24:27], 0 offen  lds
    s_add_u32 m0, s55, 24576
    s_mov_b32 s56, 811008
    buffer_load_dwordx4 v5, s[28:31], s56 offen  lds
    buffer_load_dwordx4 v5, s[28:31], s56 offen offset:1024  lds
    buffer_load_dwordx4 v[196:199], v54, s[20:23], s53 offen offset:64
    buffer_load_dwordx4 v[200:203], v54, s[20:23], s53 offen offset:128
    buffer_load_dwordx4 v[204:207], v54, s[20:23], s53 offen offset:192
    buffer_load_dwordx4 v[208:211], v54, s[20:23], s53 offen offset:256
    buffer_load_dwordx4 v[20:23], v54, s[20:23], s53 offen offset:320
    s_waitcnt vmcnt(16)
    v_lshlrev_b32 v140, 16, v92
    v_and_b32 v141, 0xffff0000, v92
    v_lshlrev_b32 v142, 16, v93
    v_and_b32 v143, 0xffff0000, v93
    v_lshlrev_b32 v148, 16, v92
    v_and_b32 v149, 0xffff0000, v92
    v_lshlrev_b32 v150, 16, v93
    v_and_b32 v151, 0xffff0000, v93
    v_lshlrev_b32 v156, 16, v92
    v_and_b32 v157, 0xffff0000, v92
    v_lshlrev_b32 v158, 16, v93
    v_and_b32 v159, 0xffff0000, v93
    v_lshlrev_b32 v164, 16, v92
    v_and_b32 v165, 0xffff0000, v92
    v_lshlrev_b32 v166, 16, v93
    v_and_b32 v167, 0xffff0000, v93
    v_lshlrev_b32 v144, 16, v94
    v_and_b32 v145, 0xffff0000, v94
    v_lshlrev_b32 v146, 16, v95
    v_and_b32 v147, 0xffff0000, v95
    v_lshlrev_b32 v152, 16, v94
    v_and_b32 v153, 0xffff0000, v94
    v_lshlrev_b32 v154, 16, v95
    v_and_b32 v155, 0xffff0000, v95
    v_lshlrev_b32 v160, 16, v94
    v_and_b32 v161, 0xffff0000, v94
    v_lshlrev_b32 v162, 16, v95
    v_and_b32 v163, 0xffff0000, v95
    v_lshlrev_b32 v168, 16, v94
    v_and_b32 v169, 0xffff0000, v94
    v_lshlrev_b32 v170, 16, v95
    v_and_b32 v171, 0xffff0000, v95
    s_waitcnt vmcnt(15)
    s_barrier
    s_cmp_eq_u32 s52, 1
    s_cbranch_scc1 L_w1
    s_cmp_eq_u32 s52, 2
    s_cbranch_scc1 L_w2
    s_cmp_eq_u32 s52, 3
    s_cbranch_scc1 L_w3
    ds_read_b64 v[108:109], v49 offset:0
    ds_read_b64 v[116:117], v49 offset:6432
    ds_read_b64_tr_b16 v[118:119], v50 offset:3264
    ds_read_b64 v[124:125], v49 offset:9664
    ds_read_b64_tr_b16 v[126:127], v50 offset:6496
    ds_read_b64 v[132:133], v49 offset:12864
    ds_read_b64_tr_b16 v[134:135], v50 offset:6528
    s_add_u32 m0, s54, 16512
    v_add_u32_dpp v7, v192, v6 quad_perm:[0,0,0,0] row_mask:0xf bank_mask:0xf
    buffer_load_dwordx4 v7, s[24:27], 0 offen  lds
    s_waitcnt lgkmcnt(0)
    v_lshlrev_b32 v112, 16, v108
    v_and_b32 v113, 0xffff0000, v108
    v_lshlrev_b32 v114, 16, v109
    v_and_b32 v115, 0xffff0000, v109
    ds_write_b128 v51, v[112:115] offset:0
    s_add_u32 m0, s54, 20640
    v_add_u32_dpp v7, v193, v6 quad_perm:[0,0,0,0] row_mask:0xf bank_mask:0xf
    buffer_load_dwordx4 v7, s[24:27], 0 offen  lds
    v_lshlrev_b32 v120, 16, v116
    v_and_b32 v121, 0xffff0000, v116
    v_lshlrev_b32 v122, 16, v117
    v_and_b32 v123, 0xffff0000, v117
    v_lshlrev_b32 v116, 16, v118
    v_and_b32 v118, 0xffff0000, v118
    v_lshlrev_b32 v117, 16, v119
    v_and_b32 v119, 0xffff0000, v119
    v_add_f32 v120, v120, v116
    v_add_f32 v121, v121, v118
    v_add_f32 v122, v122, v117
    v_add_f32 v123, v123, v119
    ds_write_b128 v51, v[120:123] offset:4096
    v_lshlrev_b32 v128, 16, v124
    v_and_b32 v129, 0xffff0000, v124
    v_lshlrev_b32 v130, 16, v125
    v_and_b32 v131, 0xffff0000, v125
    v_lshlrev_b32 v124, 16, v126
    v_and_b32 v126, 0xffff0000, v126
    v_lshlrev_b32 v125, 16, v127
    v_and_b32 v127, 0xffff0000, v127
    v_add_f32 v128, v128, v124
    v_add_f32 v129, v129, v126
    v_add_f32 v130, v130, v125
    v_add_f32 v131, v131, v127
    ds_write_b128 v51, v[128:131] offset:8192
    v_lshlrev_b32 v136, 16, v132
    v_and_b32 v137, 0xffff0000, v132
    v_lshlrev_b32 v138, 16, v133
    v_and_b32 v139, 0xffff0000, v133
    v_lshlrev_b32 v132, 16, v134
    v_and_b32 v134, 0xffff0000, v134
    v_lshlrev_b32 v133, 16, v135
    v_and_b32 v135, 0xffff0000, v135
    v_add_f32 v136, v136, v132
    v_add_f32 v137, v137, v134
    v_add_f32 v138, v138, v133
    v_add_f32 v139, v139, v135
    ds_write_b128 v51, v[136:139] offset:12288
    ds_read_b64 v[108:109], v49 offset:16032
    ds_read_b64_tr_b16 v[110:111], v50 offset:3360
    ds_read_b64 v[116:117], v49 offset:16160
    s_waitcnt lgkmcnt(0)
    v_lshlrev_b32 v112, 16, v108
    v_and_b32 v113, 0xffff0000, v108
    v_lshlrev_b32 v114, 16, v109
    v_and_b32 v115, 0xffff0000, v109
    v_lshlrev_b32 v108, 16, v110
    v_and_b32 v110, 0xffff0000, v110
    v_lshlrev_b32 v109, 16, v111
    v_and_b32 v111, 0xffff0000, v111
    v_add_f32 v112, v112, v108
    v_add_f32 v113, v113, v110
    v_add_f32 v114, v114, v109
    v_add_f32 v115, v115, v111
    ds_write_b128 v51, v[112:115] offset:16384
    v_lshlrev_b32 v120, 16, v116
    v_and_b32 v121, 0xffff0000, v116
    v_lshlrev_b32 v122, 16, v117
    v_and_b32 v123, 0xffff0000, v117
    ds_write_b128 v51, v[120:123] offset:20480
    s_branch L_join
L_w1:
    v_and_b32 v17, 15, v44
    v_mul_u32_u24 v52, 200, v17
    v_mul_u32_u24 v53, 3200, v11
    v_add3_u32 v52, v52, v53, 64
    v_add_u32 v52, 78560, v52
    v_mul_u32_u24 v53, 200, v48
    v_lshl_add_u32 v53, v47, 3, v53
    v_lshl_add_u32 v53, v11, 5, v53
    v_add_u32 v53, 97632, v53
    v_mul_u32_u24 v57, 272, v11
    v_lshl_add_u32 v57, v17, 4, v57
    v_add_u32 v57, 161536, v57
    ds_read_b64 v[108:109], v49 offset:3200
    ds_read_b64_tr_b16 v[110:111], v50 offset:32
    ds_read_b64 v[116:117], v49 offset:6464
    ds_read_b64 v[124:125], v49 offset:9696
    ds_read_b64 v[132:133], v49 offset:12896
    ds_read_b64_tr_b16 v[134:135], v50 offset:9728
    s_add_u32 m0, s54, 16512
    v_add_u32_dpp v7, v192, v6 quad_perm:[0,0,0,0] row_mask:0xf bank_mask:0xf
    buffer_load_dwordx4 v7, s[24:27], 0 offen  lds
    s_waitcnt lgkmcnt(0)
    v_lshlrev_b32 v112, 16, v108
    v_and_b32 v113, 0xffff0000, v108
    v_lshlrev_b32 v114, 16, v109
    v_and_b32 v115, 0xffff0000, v109
    v_lshlrev_b32 v108, 16, v110
    v_and_b32 v110, 0xffff0000, v110
    v_lshlrev_b32 v109, 16, v111
    v_and_b32 v111, 0xffff0000, v111
    v_add_f32 v112, v112, v108
    v_add_f32 v113, v113, v110
    v_add_f32 v114, v114, v109
    v_add_f32 v115, v115, v111
    ds_write_b128 v51, v[112:115] offset:1024
    s_add_u32 m0, s54, 20640
    v_add_u32_dpp v7, v193, v6 quad_perm:[0,0,0,0] row_mask:0xf bank_mask:0xf
    buffer_load_dwordx4 v7, s[24:27], 0 offen  lds
    v_lshlrev_b32 v120, 16, v116
    v_and_b32 v121, 0xffff0000, v116
    v_lshlrev_b32 v122, 16, v117
    v_and_b32 v123, 0xffff0000, v117
    ds_write_b128 v51, v[120:123] offset:5120
    v_lshlrev_b32 v128, 16, v124
    v_and_b32 v129, 0xffff0000, v124
    v_lshlrev_b32 v130, 16, v125
    v_and_b32 v131, 0xffff0000, v125
    ds_write_b128 v51, v[128:131] offset:9216
    v_lshlrev_b32 v136, 16, v132
    v_and_b32 v137, 0xffff0000, v132
    v_lshlrev_b32 v138, 16, v133
    v_and_b32 v139, 0xffff0000, v133
    v_lshlrev_b32 v132, 16, v134
    v_and_b32 v134, 0xffff0000, v134
    v_lshlrev_b32 v133, 16, v135
    v_and_b32 v135, 0xffff0000, v135
    v_add_f32 v136, v136, v132
    v_add_f32 v137, v137, v134
    v_add_f32 v138, v138, v133
    v_add_f32 v139, v139, v135
    ds_write_b128 v51, v[136:139] offset:13312
    ds_read_b64 v[108:109], v49 offset:16064
    ds_read_b64_tr_b16 v[110:111], v50 offset:6560
    ds_read_b64 v[116:117], v52
    ds_read_b64_tr_b16 v[118:119], v53
    s_waitcnt lgkmcnt(0)
    v_lshlrev_b32 v112, 16, v108
    v_and_b32 v113, 0xffff0000, v108
    v_lshlrev_b32 v114, 16, v109
    v_and_b32 v115, 0xffff0000, v109
    v_lshlrev_b32 v108, 16, v110
    v_and_b32 v110, 0xffff0000, v110
    v_lshlrev_b32 v109, 16, v111
    v_and_b32 v111, 0xffff0000, v111
    v_add_f32 v112, v112, v108
    v_add_f32 v113, v113, v110
    v_add_f32 v114, v114, v109
    v_add_f32 v115, v115, v111
    ds_write_b128 v51, v[112:115] offset:17408
    v_lshlrev_b32 v120, 16, v116
    v_and_b32 v121, 0xffff0000, v116
    v_lshlrev_b32 v122, 16, v117
    v_and_b32 v123, 0xffff0000, v117
    v_lshlrev_b32 v116, 16, v118
    v_and_b32 v118, 0xffff0000, v118
    v_lshlrev_b32 v117, 16, v119
    v_and_b32 v119, 0xffff0000, v119
    v_add_f32 v120, v120, v116
    v_add_f32 v121, v121, v118
    v_add_f32 v122, v122, v117
    v_add_f32 v123, v123, v119
    ds_write_b128 v57, v[120:123]
    s_branch L_join
L_w2:
    v_and_b32 v17, 15, v44
    v_mul_u32_u24 v52, 200, v17
    v_mul_u32_u24 v53, 3200, v11
    v_add3_u32 v52, v52, v53, 64
    v_add_u32 v52, 91360, v52
    v_mul_u32_u24 v53, 200, v48
    v_lshl_add_u32 v53, v47, 3, v53
    v_lshl_add_u32 v53, v11, 5, v53
    v_add_u32 v53, 97760, v53
    v_mul_u32_u24 v57, 272, v11
    v_lshl_add_u32 v57, v17, 4, v57
    v_add_u32 v57, 162624, v57
    ds_read_b64 v[108:109], v49 offset:3232
    ds_read_b64 v[116:117], v49 offset:9600
    ds_read_b64_tr_b16 v[118:119], v50 offset:96
    ds_read_b64 v[124:125], v49 offset:12800
    ds_read_b64_tr_b16 v[126:127], v50 offset:128
    ds_read_b64 v[132:133], v49 offset:12928
    s_add_u32 m0, s54, 16512
    v_add_u32_dpp v7, v192, v6 quad_perm:[0,0,0,0] row_mask:0xf bank_mask:0xf
    buffer_load_dwordx4 v7, s[24:27], 0 offen  lds
    s_waitcnt lgkmcnt(0)
    v_lshlrev_b32 v112, 16, v108
    v_and_b32 v113, 0xffff0000, v108
    v_lshlrev_b32 v114, 16, v109
    v_and_b32 v115, 0xffff0000, v109
    ds_write_b128 v51, v[112:115] offset:2048
    s_add_u32 m0, s54, 20640
    v_add_u32_dpp v7, v193, v6 quad_perm:[0,0,0,0] row_mask:0xf bank_mask:0xf
    buffer_load_dwordx4 v7, s[24:27], 0 offen  lds
    v_lshlrev_b32 v120, 16, v116
    v_and_b32 v121, 0xffff0000, v116
    v_lshlrev_b32 v122, 16, v117
    v_and_b32 v123, 0xffff0000, v117
    v_lshlrev_b32 v116, 16, v118
    v_and_b32 v118, 0xffff0000, v118
    v_lshlrev_b32 v117, 16, v119
    v_and_b32 v119, 0xffff0000, v119
    v_add_f32 v120, v120, v116
    v_add_f32 v121, v121, v118
    v_add_f32 v122, v122, v117
    v_add_f32 v123, v123, v119
    ds_write_b128 v51, v[120:123] offset:6144
    v_lshlrev_b32 v128, 16, v124
    v_and_b32 v129, 0xffff0000, v124
    v_lshlrev_b32 v130, 16, v125
    v_and_b32 v131, 0xffff0000, v125
    v_lshlrev_b32 v124, 16, v126
    v_and_b32 v126, 0xffff0000, v126
    v_lshlrev_b32 v125, 16, v127
    v_and_b32 v127, 0xffff0000, v127
    v_add_f32 v128, v128, v124
    v_add_f32 v129, v129, v126
    v_add_f32 v130, v130, v125
    v_add_f32 v131, v131, v127
    ds_write_b128 v51, v[128:131] offset:10240
    v_lshlrev_b32 v136, 16, v132
    v_and_b32 v137, 0xffff0000, v132
    v_lshlrev_b32 v138, 16, v133
    v_and_b32 v139, 0xffff0000, v133
    ds_write_b128 v51, v[136:139] offset:14336
    ds_read_b64 v[108:109], v49 offset:16096
    ds_read_b64_tr_b16 v[110:111], v50 offset:9760
    ds_read_b64 v[116:117], v52
    ds_read_b64_tr_b16 v[118:119], v53
    s_waitcnt lgkmcnt(0)
    v_lshlrev_b32 v112, 16, v108
    v_and_b32 v113, 0xffff0000, v108
    v_lshlrev_b32 v114, 16, v109
    v_and_b32 v115, 0xffff0000, v109
    v_lshlrev_b32 v108, 16, v110
    v_and_b32 v110, 0xffff0000, v110
    v_lshlrev_b32 v109, 16, v111
    v_and_b32 v111, 0xffff0000, v111
    v_add_f32 v112, v112, v108
    v_add_f32 v113, v113, v110
    v_add_f32 v114, v114, v109
    v_add_f32 v115, v115, v111
    ds_write_b128 v51, v[112:115] offset:18432
    v_lshlrev_b32 v120, 16, v116
    v_and_b32 v121, 0xffff0000, v116
    v_lshlrev_b32 v122, 16, v117
    v_and_b32 v123, 0xffff0000, v117
    v_lshlrev_b32 v116, 16, v118
    v_and_b32 v118, 0xffff0000, v118
    v_lshlrev_b32 v117, 16, v119
    v_and_b32 v119, 0xffff0000, v119
    v_add_f32 v120, v120, v116
    v_add_f32 v121, v121, v118
    v_add_f32 v122, v122, v117
    v_add_f32 v123, v123, v119
    s_mov_b32 exec_hi, 0
    ds_write_b128 v57, v[120:123]
    s_mov_b64 exec, -1
    s_branch L_join
L_w3:
    v_mul_u32_u24 v52, 200, v47
    v_add_u32 v52, 97824, v52
    v_lshlrev_b32 v57, 4, v47
    v_add_u32 v57, 163168, v57
    ds_read_b64 v[108:109], v49 offset:6400
    ds_read_b64_tr_b16 v[110:111], v50 offset:64
    ds_read_b64 v[116:117], v49 offset:9632
    ds_read_b64_tr_b16 v[118:119], v50 offset:3296
    ds_read_b64 v[124:125], v49 offset:12832
    ds_read_b64_tr_b16 v[126:127], v50 offset:3328
    ds_read_b64 v[132:133], v49 offset:16000
    ds_read_b64_tr_b16 v[134:135], v50 offset:160
    s_add_u32 m0, s54, 16512
    v_add_u32_dpp v7, v192, v6 quad_perm:[0,0,0,0] row_mask:0xf bank_mask:0xf
    buffer_load_dwordx4 v7, s[24:27], 0 offen  lds
    s_waitcnt lgkmcnt(0)
    v_lshlrev_b32 v112, 16, v108
    v_and_b32 v113, 0xffff0000, v108
    v_lshlrev_b32 v114, 16, v109
    v_and_b32 v115, 0xffff0000, v109
    v_lshlrev_b32 v108, 16, v110
    v_and_b32 v110, 0xffff0000, v110
    v_lshlrev_b32 v109, 16, v111
    v_and_b32 v111, 0xffff0000, v111
    v_add_f32 v112, v112, v108
    v_add_f32 v113, v113, v110
    v_add_f32 v114, v114, v109
    v_add_f32 v115, v115, v111
    ds_write_b128 v51, v[112:115] offset:3072
    s_add_u32 m0, s54, 20640
    v_add_u32_dpp v7, v193, v6 quad_perm:[0,0,0,0] row_mask:0xf bank_mask:0xf
    buffer_load_dwordx4 v7, s[24:27], 0 offen  lds
    v_lshlrev_b32 v120, 16, v116
    v_and_b32 v121, 0xffff0000, v116
    v_lshlrev_b32 v122, 16, v117
    v_and_b32 v123, 0xffff0000, v117
    v_lshlrev_b32 v116, 16, v118
    v_and_b32 v118, 0xffff0000, v118
    v_lshlrev_b32 v117, 16, v119
    v_and_b32 v119, 0xffff0000, v119
    v_add_f32 v120, v120, v116
    v_add_f32 v121, v121, v118
    v_add_f32 v122, v122, v117
    v_add_f32 v123, v123, v119
    ds_write_b128 v51, v[120:123] offset:7168
    v_lshlrev_b32 v128, 16, v124
    v_and_b32 v129, 0xffff0000, v124
    v_lshlrev_b32 v130, 16, v125
    v_and_b32 v131, 0xffff0000, v125
    v_lshlrev_b32 v124, 16, v126
    v_and_b32 v126, 0xffff0000, v126
    v_lshlrev_b32 v125, 16, v127
    v_and_b32 v127, 0xffff0000, v127
    v_add_f32 v128, v128, v124
    v_add_f32 v129, v129, v126
    v_add_f32 v130, v130, v125
    v_add_f32 v131, v131, v127
    ds_write_b128 v51, v[128:131] offset:11264
    v_lshlrev_b32 v136, 16, v132
    v_and_b32 v137, 0xffff0000, v132
    v_lshlrev_b32 v138, 16, v133
    v_and_b32 v139, 0xffff0000, v133
    v_lshlrev_b32 v132, 16, v134
    v_and_b32 v134, 0xffff0000, v134
    v_lshlrev_b32 v133, 16, v135
    v_and_b32 v135, 0xffff0000, v135
    v_add_f32 v136, v136, v132
    v_add_f32 v137, v137, v134
    v_add_f32 v138, v138, v133
    v_add_f32 v139, v139, v135
    ds_write_b128 v51, v[136:139] offset:15360
    ds_read_b64 v[108:109], v49 offset:16128
    ds_read_b64_tr_b16 v[110:111], v50 offset:12960
    ds_read_b64 v[116:117], v52
    s_waitcnt lgkmcnt(0)
    v_lshlrev_b32 v112, 16, v108
    v_and_b32 v113, 0xffff0000, v108
    v_lshlrev_b32 v114, 16, v109
    v_and_b32 v115, 0xffff0000, v109
    v_lshlrev_b32 v108, 16, v110
    v_and_b32 v110, 0xffff0000, v110
    v_lshlrev_b32 v109, 16, v111
    v_and_b32 v111, 0xffff0000, v111
    v_add_f32 v112, v112, v108
    v_add_f32 v113, v113, v110
    v_add_f32 v114, v114, v109
    v_add_f32 v115, v115, v111
    ds_write_b128 v51, v[112:115] offset:19456
    v_lshlrev_b32 v120, 16, v116
    v_and_b32 v121, 0xffff0000, v116
    v_lshlrev_b32 v122, 16, v117
    v_and_b32 v123, 0xffff0000, v117
    s_mov_b64 exec, 15
    ds_write_b128 v57, v[120:123]
    s_mov_b64 exec, -1
L_join:
    v_lshlrev_b32 v28, 4, v48
    v_lshl_add_u32 v28, v11, 2, v28
    v_add_u32 v28, 163168, v28
    v_lshlrev_b32 v11, 4, v11
    v_add_u32 v12, 140032, v12
    s_waitcnt vmcnt(14) lgkmcnt(0)
    s_barrier
    ds_read_b64_tr_b16 v[92:93], v4 offset:0
    ds_read_b128 v[108:111], v0 offset:0
    ds_read_b64_tr_b16 v[94:95], v4 offset:1024
    ds_read_b128 v[112:115], v0 offset:1024
    ds_read_b64_tr_b16 v[96:97], v2 offset:0
    ds_read_b128 v[116:119], v0 offset:2048
    ds_read_b64_tr_b16 v[98:99], v2 offset:1024
    ds_read_b128 v[120:123], v0 offset:3072
    ds_read_b32 v76, v28
    ds_read_b32 v61, v13
    ds_read_b128 v[68:71], v12
    s_waitcnt vmcnt(9)
    ds_read_b128 v[172:175], v55 offset:0
    ds_read_b128 v[176:179], v55 offset:64
    ds_read_b128 v[180:183], v55 offset:128
    ds_read_b128 v[184:187], v55 offset:192
    s_mov_b32 vcc_lo, 0x11111111
    s_mov_b32 vcc_hi, 0x11111111
    s_waitcnt lgkmcnt(6)
    v_cndmask_b32 v72, 0, v76, vcc
    s_mov_b32 vcc_lo, 0x22222222
    s_mov_b32 vcc_hi, 0x22222222
    v_cndmask_b32 v73, 0, v76, vcc
    s_mov_b32 vcc_lo, 0x44444444
    s_mov_b32 vcc_hi, 0x44444444
    v_cndmask_b32 v74, 0, v76, vcc
    s_mov_b32 vcc_lo, 0x88888888
    s_mov_b32 vcc_hi, 0x88888888
    v_cndmask_b32 v75, 0, v76, vcc
L_step0:
    v_mfma_f32_16x16x32_bf16 v[140:143], v[92:95], v[108:111], v[140:143]
    s_barrier
    s_add_u32 m0, s55, 32768
    s_mov_b32 s56, 0
    v_mfma_f32_16x16x32_bf16 v[148:151], v[92:95], v[112:115], v[148:151]
    buffer_load_dwordx4 v5, s[28:31], s56 offen  lds
    buffer_load_dwordx4 v5, s[28:31], s56 offen offset:1024  lds
    ds_read_b64_tr_b16 v[100:101], v4 offset:8192
    s_add_u32 m0, s54, 24768
    v_add_u32_dpp v7, v194, v6 quad_perm:[0,0,0,0] row_mask:0xf bank_mask:0xf
    v_mfma_f32_16x16x32_bf16 v[152:155], v[96:99], v[112:115], v[152:155]
    ds_read_b128 v[124:127], v0 offset:4128
    buffer_load_dwordx4 v7, s[24:27], 0 offen  lds
    ds_read_b64_tr_b16 v[102:103], v4 offset:9216
    s_add_u32 m0, s54, 28896
    v_add_u32_dpp v7, v195, v6 quad_perm:[0,0,0,0] row_mask:0xf bank_mask:0xf
    v_mfma_f32_16x16x32_bf16 v[144:147], v[96:99], v[108:111], v[144:147]
    ds_read_b128 v[128:131], v0 offset:5152
    buffer_load_dwordx4 v7, s[24:27], 0 offen  lds
    ds_read_b64_tr_b16 v[104:105], v2 offset:8192
    v_add_u32 v190, L_step8-L_pc, v189
    v_mfma_f32_16x16x32_bf16 v[160:163], v[96:99], v[116:119], v[160:163]
    ds_read_b128 v[132:135], v0 offset:6176
    ds_read_b64_tr_b16 v[106:107], v2 offset:9216
    v_mfma_f32_16x16x32_bf16 v[156:159], v[92:95], v[116:119], v[156:159]
    ds_read_b128 v[136:139], v0 offset:7200
    s_waitcnt lgkmcnt(11)
    v_mfma_f32_16x16x32_bf16 v[28:31], v[172:175], v[172:175], 0
    global_load_dword v190, v190, s[62:63]
    v_mfma_f32_16x16x32_bf16 v[164:167], v[92:95], v[120:123], v[164:167]
    v_mfma_f32_16x16x32_bf16 v[168:171], v[96:99], v[120:123], v[168:171]
L_step1:
    s_waitcnt vmcnt(7) lgkmcnt(0)
    v_mfma_f32_16x16x32_bf16 v[140:143], v[100:103], v[124:127], v[140:143]
    s_barrier
    ds_read_b64_tr_b16 v[92:93], v4 offset:16384
    ds_read_b128 v[108:111], v0 offset:8256
    s_add_u32 m0, s55, 0
    s_mov_b32 s56, 8192
    v_mfma_f32_16x16x32_bf16 v[148:151], v[100:103], v[128:131], v[148:151]
    buffer_load_dwordx4 v5, s[28:31], s56 offen  lds
    ds_read_b64_tr_b16 v[94:95], v4 offset:17408
    v_mfma_f32_16x16x32_bf16 v[152:155], v[104:107], v[128:131], v[152:155]
    ds_read_b128 v[112:115], v0 offset:9280
    ds_read_b64_tr_b16 v[96:97], v2 offset:16384
    v_mfma_f32_16x16x32_bf16 v[144:147], v[104:107], v[124:127], v[144:147]
    ds_read_b128 v[116:119], v0 offset:10304
    ds_read_b64_tr_b16 v[98:99], v2 offset:17408
    v_mfma_f32_16x16x32_bf16 v[160:163], v[104:107], v[132:135], v[160:163]
    ds_read_b128 v[120:123], v0 offset:11328
    v_mul_f32 v44, v28, v72
    v_mfma_f32_16x16x32_bf16 v[156:159], v[100:103], v[132:135], v[156:159]
    buffer_load_dwordx4 v5, s[28:31], s56 offen offset:1024  lds
    s_add_u32 m0, s54, 33024
    v_add_u32_dpp v7, v192, v6 quad_perm:[1,1,1,1] row_mask:0xf bank_mask:0xf
    v_mfma_f32_16x16x32_bf16 v[32:35], v[176:179], v[176:179], 0
    buffer_load_dwordx4 v7, s[24:27], 0 offen  lds
    v_mul_f32 v48, v29, v73
    v_mfma_f32_16x16x32_bf16 v[164:167], v[100:103], v[136:139], v[164:167]
    v_mul_f32 v52, v30, v74
    v_mul_f32 v56, v31, v75
    v_mfma_f32_16x16x32_bf16 v[168:171], v[104:107], v[136:139], v[168:171]
    v_lshlrev_b32 v196, 6, v196
    v_lshlrev_b32 v197, 6, v197
L_step2:
    v_mul_f32 v45, v32, v72
    v_mul_f32 v49, v33, v73
    v_mul_f32 v53, v34, v74
    v_mul_f32 v57, v35, v75
    s_waitcnt lgkmcnt(0)
    v_mfma_f32_16x16x32_bf16 v[140:143], v[92:95], v[108:111], v[140:143]
    s_barrier
    ds_read_b64_tr_b16 v[100:101], v4 offset:24576
    ds_read_b128 v[124:127], v0 offset:12384
    s_add_u32 m0, s55, 8192
    s_mov_b32 s56, 16384
    v_mfma_f32_16x16x32_bf16 v[148:151], v[92:95], v[112:115], v[148:151]
    buffer_load_dwordx4 v5, s[28:31], s56 offen  lds
    ds_read_b64_tr_b16 v[102:103], v4 offset:25600
    v_mfma_f32_16x16x32_bf16 v[152:155], v[96:99], v[112:115], v[152:155]
    ds_read_b128 v[128:131], v0 offset:13408
    ds_read_b64_tr_b16 v[104:105], v2 offset:24576
    v_mfma_f32_16x16x32_bf16 v[144:147], v[96:99], v[108:111], v[144:147]
    ds_read_b128 v[132:135], v0 offset:14432
    ds_read_b64_tr_b16 v[106:107], v2 offset:25600
    v_mfma_f32_16x16x32_bf16 v[160:163], v[96:99], v[116:119], v[160:163]
    ds_read_b128 v[136:139], v0 offset:15456
    v_lshlrev_b32 v198, 6, v198
    v_mfma_f32_16x16x32_bf16 v[156:159], v[92:95], v[116:119], v[156:159]
    buffer_load_dwordx4 v5, s[28:31], s56 offen offset:1024  lds
    s_add_u32 m0, s54, 37152
    v_add_u32_dpp v7, v193, v6 quad_perm:[1,1,1,1] row_mask:0xf bank_mask:0xf
    v_mfma_f32_16x16x32_bf16 v[36:39], v[180:183], v[180:183], 0
    buffer_load_dwordx4 v7, s[24:27], 0 offen  lds
    v_lshlrev_b32 v199, 6, v199
    v_mfma_f32_16x16x32_bf16 v[164:167], v[92:95], v[120:123], v[164:167]
    v_lshlrev_b32 v200, 6, v200
    v_lshlrev_b32 v201, 6, v201
    v_mfma_f32_16x16x32_bf16 v[168:171], v[96:99], v[120:123], v[168:171]
    v_lshlrev_b32 v202, 6, v202
    v_lshlrev_b32 v203, 6, v203
L_step3:
    v_mul_f32 v46, v36, v72
    v_mul_f32 v50, v37, v73
    v_mul_f32 v54, v38, v74
    v_mul_f32 v58, v39, v75
    s_waitcnt vmcnt(9) lgkmcnt(0)
    v_mfma_f32_16x16x32_bf16 v[140:143], v[100:103], v[124:127], v[140:143]
    s_barrier
    ds_read_b64_tr_b16 v[92:93], v4 offset:32768
    ds_read_b128 v[108:111], v0 offset:16512
    s_add_u32 m0, s55, 16384
    s_mov_b32 s56, 24576
    v_mfma_f32_16x16x32_bf16 v[148:151], v[100:103], v[128:131], v[148:151]
    buffer_load_dwordx4 v5, s[28:31], s56 offen  lds
    ds_read_b64_tr_b16 v[94:95], v4 offset:33792
    v_mfma_f32_16x16x32_bf16 v[152:155], v[104:107], v[128:131], v[152:155]
    ds_read_b128 v[112:115], v0 offset:17536
    ds_read_b64_tr_b16 v[96:97], v2 offset:32768
    v_mfma_f32_16x16x32_bf16 v[144:147], v[104:107], v[124:127], v[144:147]
    ds_read_b128 v[116:119], v0 offset:18560
    ds_read_b64_tr_b16 v[98:99], v2 offset:33792
    v_mfma_f32_16x16x32_bf16 v[160:163], v[104:107], v[132:135], v[160:163]
    ds_read_b128 v[120:123], v0 offset:19584
    v_lshlrev_b32 v204, 6, v204
    v_mfma_f32_16x16x32_bf16 v[156:159], v[100:103], v[132:135], v[156:159]
    buffer_load_dwordx4 v5, s[28:31], s56 offen offset:1024  lds
    s_add_u32 m0, s54, 41280
    v_add_u32_dpp v7, v194, v6 quad_perm:[1,1,1,1] row_mask:0xf bank_mask:0xf
    v_mfma_f32_16x16x32_bf16 v[28:31], v[184:187], v[184:187], 0
    buffer_load_dwordx4 v7, s[24:27], 0 offen  lds
    v_lshlrev_b32 v205, 6, v205
    v_mfma_f32_16x16x32_bf16 v[164:167], v[100:103], v[136:139], v[164:167]
    v_lshlrev_b32 v206, 6, v206
    v_lshlrev_b32 v207, 6, v207
    v_mfma_f32_16x16x32_bf16 v[168:171], v[104:107], v[136:139], v[168:171]
    v_lshlrev_b32 v208, 6, v208
    v_lshlrev_b32 v209, 6, v209
L_step4:
    v_mul_f32 v47, v28, v72
    v_mul_f32 v51, v29, v73
    v_mul_f32 v55, v30, v74
    v_mul_f32 v59, v31, v75
    s_waitcnt vmcnt(7) lgkmcnt(0)
    v_mfma_f32_16x16x32_bf16 v[140:143], v[92:95], v[108:111], v[140:143]
    s_barrier
    ds_read_b64_tr_b16 v[100:101], v4 offset:0
    ds_read_b128 v[124:127], v0 offset:20640
    ds_read_b64_tr_b16 v[102:103], v4 offset:1024
    s_add_u32 m0, s55, 24576
    s_mov_b32 s56, 32768
    v_mfma_f32_16x16x32_bf16 v[148:151], v[92:95], v[112:115], v[148:151]
    buffer_load_dwordx4 v5, s[28:31], s56 offen  lds
    buffer_load_dwordx4 v5, s[28:31], s56 offen offset:1024  lds
    ds_read_b128 v[128:131], v0 offset:21664
    s_add_u32 m0, s54, 45408
    v_add_u32_dpp v7, v195, v6 quad_perm:[1,1,1,1] row_mask:0xf bank_mask:0xf
    v_mfma_f32_16x16x32_bf16 v[152:155], v[96:99], v[112:115], v[152:155]
    ds_read_b64_tr_b16 v[104:105], v2 offset:0
    ds_read_b128 v[132:135], v0 offset:22688
    v_mfma_f32_16x16x32_bf16 v[144:147], v[96:99], v[108:111], v[144:147]
    ds_read_b64_tr_b16 v[106:107], v2 offset:1024
    ds_read_b128 v[136:139], v0 offset:23712
    v_mfma_f32_16x16x32_bf16 v[160:163], v[96:99], v[116:119], v[160:163]
    buffer_load_dwordx4 v7, s[24:27], 0 offen  lds
    s_add_u32 m0, s54, 49536
    v_add_u32_dpp v7, v192, v6 quad_perm:[2,2,2,2] row_mask:0xf bank_mask:0xf
    v_mfma_f32_16x16x32_bf16 v[156:159], v[92:95], v[116:119], v[156:159]
    buffer_load_dwordx4 v7, s[24:27], 0 offen  lds
    v_lshlrev_b32 v210, 6, v210
    v_mfma_f32_16x16x32_bf16 v[164:167], v[92:95], v[120:123], v[164:167]
    v_lshlrev_b32 v211, 6, v211
    v_lshlrev_b32 v20, 6, v20
    v_mfma_f32_16x16x32_bf16 v[168:171], v[96:99], v[120:123], v[168:171]
    v_lshlrev_b32 v21, 6, v21
    v_lshlrev_b32 v22, 6, v22
L_step5:
    s_waitcnt vmcnt(8) lgkmcnt(0)
    v_mfma_f32_16x16x32_bf16 v[140:143], v[100:103], v[124:127], v[140:143]
    s_barrier
    ds_read_b64_tr_b16 v[92:93], v4 offset:8192
    ds_read_b128 v[108:111], v0 offset:24768
    ds_read_b64_tr_b16 v[94:95], v4 offset:9216
    s_add_u32 m0, s55, 32768
    s_mov_b32 s56, 40960
    v_mfma_f32_16x16x32_bf16 v[148:151], v[100:103], v[128:131], v[148:151]
    buffer_load_dwordx4 v5, s[28:31], s56 offen  lds
    ds_read_b128 v[112:115], v0 offset:25792
    v_mfma_f32_16x16x32_bf16 v[152:155], v[104:107], v[128:131], v[152:155]
    ds_read_b64_tr_b16 v[96:97], v2 offset:8192
    ds_read_b128 v[116:119], v0 offset:26816
    v_mfma_f32_16x16x32_bf16 v[144:147], v[104:107], v[124:127], v[144:147]
    ds_read_b64_tr_b16 v[98:99], v2 offset:9216
    ds_read_b128 v[120:123], v0 offset:27840
    v_mfma_f32_16x16x32_bf16 v[160:163], v[104:107], v[132:135], v[160:163]
    v_lshlrev_b32 v23, 6, v23
    v_mfma_f32_16x16x32_bf16 v[156:159], v[100:103], v[132:135], v[156:159]
    buffer_load_dwordx4 v5, s[28:31], s56 offen offset:1024  lds
    s_add_u32 m0, s54, 53664
    v_add_u32_dpp v7, v193, v6 quad_perm:[2,2,2,2] row_mask:0xf bank_mask:0xf
    v_mfma_f32_16x16x32_bf16 v[164:167], v[100:103], v[136:139], v[164:167]
    buffer_load_dwordx4 v7, s[24:27], 0 offen  lds
    v_mfma_f32_16x16x32_bf16 v[168:171], v[104:107], v[136:139], v[168:171]
L_step6:
    s_waitcnt vmcnt(8) lgkmcnt(0)
    v_mfma_f32_16x16x32_bf16 v[140:143], v[92:95], v[108:111], v[140:143]
    s_barrier
    ds_read_b64_tr_b16 v[100:101], v4 offset:16384
    ds_read_b128 v[124:127], v0 offset:28896
    ds_read_b64_tr_b16 v[102:103], v4 offset:17408
    s_add_u32 m0, s55, 0
    s_mov_b32 s56, 49152
    v_mfma_f32_16x16x32_bf16 v[148:151], v[92:95], v[112:115], v[148:151]
    buffer_load_dwordx4 v5, s[28:31], s56 offen  lds
    ds_read_b128 v[128:131], v0 offset:29920
    v_mfma_f32_16x16x32_bf16 v[152:155], v[96:99], v[112:115], v[152:155]
    ds_read_b64_tr_b16 v[104:105], v2 offset:16384
    ds_read_b128 v[132:135], v0 offset:30944
    v_mfma_f32_16x16x32_bf16 v[144:147], v[96:99], v[108:111], v[144:147]
    ds_read_b64_tr_b16 v[106:107], v2 offset:17408
    ds_read_b128 v[136:139], v0 offset:31968
    v_mfma_f32_16x16x32_bf16 v[160:163], v[96:99], v[116:119], v[160:163]
    v_mfma_f32_16x16x32_bf16 v[156:159], v[92:95], v[116:119], v[156:159]
    buffer_load_dwordx4 v5, s[28:31], s56 offen offset:1024  lds
    s_add_u32 m0, s54, 57792
    v_add_u32_dpp v7, v194, v6 quad_perm:[2,2,2,2] row_mask:0xf bank_mask:0xf
    v_mfma_f32_16x16x32_bf16 v[164:167], v[92:95], v[120:123], v[164:167]
    buffer_load_dwordx4 v7, s[24:27], 0 offen  lds
    v_mfma_f32_16x16x32_bf16 v[168:171], v[96:99], v[120:123], v[168:171]
L_step7:
    s_waitcnt vmcnt(8) lgkmcnt(0)
    v_mfma_f32_16x16x32_bf16 v[140:143], v[100:103], v[124:127], v[140:143]
    s_barrier
    ds_read_b64_tr_b16 v[92:93], v4 offset:24576
    ds_read_b128 v[108:111], v0 offset:33024
    ds_read_b64_tr_b16 v[94:95], v4 offset:25600
    s_add_u32 m0, s55, 8192
    s_mov_b32 s56, 57344
    v_mfma_f32_16x16x32_bf16 v[148:151], v[100:103], v[128:131], v[148:151]
    buffer_load_dwordx4 v5, s[28:31], s56 offen  lds
    ds_read_b128 v[112:115], v0 offset:34048
    v_mfma_f32_16x16x32_bf16 v[152:155], v[104:107], v[128:131], v[152:155]
    ds_read_b64_tr_b16 v[96:97], v2 offset:24576
    ds_read_b128 v[116:119], v0 offset:35072
    v_mfma_f32_16x16x32_bf16 v[144:147], v[104:107], v[124:127], v[144:147]
    ds_read_b64_tr_b16 v[98:99], v2 offset:25600
    ds_read_b128 v[120:123], v0 offset:36096
    v_mfma_f32_16x16x32_bf16 v[160:163], v[104:107], v[132:135], v[160:163]
    v_mfma_f32_16x16x32_bf16 v[156:159], v[100:103], v[132:135], v[156:159]
    buffer_load_dwordx4 v5, s[28:31], s56 offen offset:1024  lds
    s_add_u32 m0, s54, 61920
    v_add_u32_dpp v7, v195, v6 quad_perm:[2,2,2,2] row_mask:0xf bank_mask:0xf
    v_mfma_f32_16x16x32_bf16 v[164:167], v[100:103], v[136:139], v[164:167]
    buffer_load_dwordx4 v7, s[24:27], 0 offen  lds
    v_mfma_f32_16x16x32_bf16 v[168:171], v[104:107], v[136:139], v[168:171]
L_step8:
    s_waitcnt vmcnt(7) lgkmcnt(0)
    v_mfma_f32_16x16x32_bf16 v[140:143], v[92:95], v[108:111], v[140:143]
    s_barrier
    ds_read_b64_tr_b16 v[100:101], v4 offset:32768
    ds_read_b128 v[124:127], v0 offset:37152
    ds_read_b64_tr_b16 v[102:103], v4 offset:33792
    s_add_u32 m0, s55, 16384
    s_mov_b32 s56, 65536
    v_mfma_f32_16x16x32_bf16 v[148:151], v[92:95], v[112:115], v[148:151]
    buffer_load_dwordx4 v5, s[28:31], s56 offen  lds
    buffer_load_dwordx4 v5, s[28:31], s56 offen offset:1024  lds
    ds_read_b128 v[128:131], v0 offset:38176
    s_add_u32 m0, s54, 66048
    v_add_u32_dpp v7, v192, v6 quad_perm:[3,3,3,3] row_mask:0xf bank_mask:0xf
    v_mfma_f32_16x16x32_bf16 v[152:155], v[96:99], v[112:115], v[152:155]
    ds_read_b64_tr_b16 v[104:105], v2 offset:32768
    ds_read_b128 v[132:135], v0 offset:39200
    v_mfma_f32_16x16x32_bf16 v[144:147], v[96:99], v[108:111], v[144:147]
    ds_read_b64_tr_b16 v[106:107], v2 offset:33792
    ds_read_b128 v[136:139], v0 offset:40224
    v_mfma_f32_16x16x32_bf16 v[160:163], v[96:99], v[116:119], v[160:163]
    buffer_load_dwordx4 v7, s[24:27], 0 offen  lds
    s_add_u32 m0, s54, 70176
    v_add_u32_dpp v7, v193, v6 quad_perm:[3,3,3,3] row_mask:0xf bank_mask:0xf
    v_mfma_f32_16x16x32_bf16 v[156:159], v[92:95], v[116:119], v[156:159]
    buffer_load_dwordx4 v7, s[24:27], 0 offen  lds
    v_mfma_f32_16x16x32_bf16 v[164:167], v[92:95], v[120:123], v[164:167]
    v_mfma_f32_16x16x32_bf16 v[168:171], v[96:99], v[120:123], v[168:171]
L_step9:
    s_waitcnt vmcnt(8) lgkmcnt(0)
    v_mfma_f32_16x16x32_bf16 v[140:143], v[100:103], v[124:127], v[140:143]
    s_barrier
    ds_read_b64_tr_b16 v[92:93], v4 offset:0
    ds_read_b128 v[108:111], v0 offset:41280
    ds_read_b64_tr_b16 v[94:95], v4 offset:1024
    s_add_u32 m0, s55, 24576
    s_mov_b32 s56, 73728
    v_mfma_f32_16x16x32_bf16 v[148:151], v[100:103], v[128:131], v[148:151]
    buffer_load_dwordx4 v5, s[28:31], s56 offen  lds
    ds_read_b128 v[112:115], v0 offset:42304
    v_mfma_f32_16x16x32_bf16 v[152:155], v[104:107], v[128:131], v[152:155]
    ds_read_b64_tr_b16 v[96:97], v2 offset:0
    ds_read_b128 v[116:119], v0 offset:43328
    v_mfma_f32_16x16x32_bf16 v[144:147], v[104:107], v[124:127], v[144:147]
    ds_read_b64_tr_b16 v[98:99], v2 offset:1024
    ds_read_b128 v[120:123], v0 offset:44352
    v_mfma_f32_16x16x32_bf16 v[160:163], v[104:107], v[132:135], v[160:163]
    v_mfma_f32_16x16x32_bf16 v[156:159], v[100:103], v[132:135], v[156:159]
    buffer_load_dwordx4 v5, s[28:31], s56 offen offset:1024  lds
    s_add_u32 m0, s54, 74304
    v_add_u32_dpp v7, v194, v6 quad_perm:[3,3,3,3] row_mask:0xf bank_mask:0xf
    v_mfma_f32_16x16x32_bf16 v[164:167], v[100:103], v[136:139], v[164:167]
    buffer_load_dwordx4 v7, s[24:27], 0 offen  lds
    v_mfma_f32_16x16x32_bf16 v[168:171], v[104:107], v[136:139], v[168:171]
L_step10:
    s_waitcnt vmcnt(8) lgkmcnt(0)
    v_mfma_f32_16x16x32_bf16 v[140:143], v[92:95], v[108:111], v[140:143]
    s_barrier
    ds_read_b64_tr_b16 v[100:101], v4 offset:8192
    ds_read_b128 v[124:127], v0 offset:45408
    ds_read_b64_tr_b16 v[102:103], v4 offset:9216
    s_add_u32 m0, s55, 32768
    s_mov_b32 s56, 81920
    v_mfma_f32_16x16x32_bf16 v[148:151], v[92:95], v[112:115], v[148:151]
    buffer_load_dwordx4 v5, s[28:31], s56 offen  lds
    buffer_load_dwordx4 v5, s[28:31], s56 offen offset:1024  lds
    ds_read_b128 v[128:131], v0 offset:46432
    s_add_u32 m0, s54, 78432
    v_add_u32_dpp v7, v195, v6 quad_perm:[3,3,3,3] row_mask:0xf bank_mask:0xf
    v_mfma_f32_16x16x32_bf16 v[152:155], v[96:99], v[112:115], v[152:155]
    ds_read_b64_tr_b16 v[104:105], v2 offset:8192
    ds_read_b128 v[132:135], v0 offset:47456
    v_mfma_f32_16x16x32_bf16 v[144:147], v[96:99], v[108:111], v[144:147]
    ds_read_b64_tr_b16 v[106:107], v2 offset:9216
    ds_read_b128 v[136:139], v0 offset:48480
    v_mfma_f32_16x16x32_bf16 v[160:163], v[96:99], v[116:119], v[160:163]
    buffer_load_dwordx4 v7, s[24:27], 0 offen  lds
    v_add_u32 v190, L_step18-L_pc, v189
    v_mfma_f32_16x16x32_bf16 v[156:159], v[92:95], v[116:119], v[156:159]
    global_load_dword v190, v190, s[62:63]
    v_mfma_f32_16x16x32_bf16 v[164:167], v[92:95], v[120:123], v[164:167]
    v_mfma_f32_16x16x32_bf16 v[168:171], v[96:99], v[120:123], v[168:171]
L_step11:
    s_waitcnt vmcnt(9) lgkmcnt(0)
    v_mfma_f32_16x16x32_bf16 v[140:143], v[100:103], v[124:127], v[140:143]
    s_barrier
    ds_read_b64_tr_b16 v[92:93], v4 offset:16384
    ds_read_b128 v[108:111], v1 offset:0
    ds_read_b64_tr_b16 v[94:95], v4 offset:17408
    s_add_u32 m0, s55, 0
    s_mov_b32 s56, 90112
    v_mfma_f32_16x16x32_bf16 v[148:151], v[100:103], v[128:131], v[148:151]
    buffer_load_dwordx4 v5, s[28:31], s56 offen  lds
    ds_read_b128 v[112:115], v1 offset:1024
    v_mfma_f32_16x16x32_bf16 v[152:155], v[104:107], v[128:131], v[152:155]
    ds_read_b64_tr_b16 v[96:97], v2 offset:16384
    ds_read_b128 v[116:119], v1 offset:2048
    v_mfma_f32_16x16x32_bf16 v[144:147], v[104:107], v[124:127], v[144:147]
    ds_read_b64_tr_b16 v[98:99], v2 offset:17408
    ds_read_b128 v[120:123], v1 offset:3072
    v_mfma_f32_16x16x32_bf16 v[160:163], v[104:107], v[132:135], v[160:163]
    v_mfma_f32_16x16x32_bf16 v[156:159], v[100:103], v[132:135], v[156:159]
    buffer_load_dwordx4 v5, s[28:31], s56 offen offset:1024  lds
    s_add_u32 m0, s54, 82560
    v_add_u32_dpp v7, v196, v6 quad_perm:[0,0,0,0] row_mask:0xf bank_mask:0xf
    v_mfma_f32_16x16x32_bf16 v[164:167], v[100:103], v[136:139], v[164:167]
    buffer_load_dwordx4 v7, s[24:27], 0 offen  lds
    v_mfma_f32_16x16x32_bf16 v[168:171], v[104:107], v[136:139], v[168:171]
L_step12:
    s_waitcnt vmcnt(8) lgkmcnt(0)
    v_mfma_f32_16x16x32_bf16 v[140:143], v[92:95], v[108:111], v[140:143]
    s_barrier
    ds_read_b64_tr_b16 v[100:101], v4 offset:24576
    ds_read_b128 v[124:127], v1 offset:4128
    ds_read_b64_tr_b16 v[102:103], v4 offset:25600
    s_add_u32 m0, s55, 8192
    s_mov_b32 s56, 98304
    v_mfma_f32_16x16x32_bf16 v[148:151], v[92:95], v[112:115], v[148:151]
    buffer_load_dwordx4 v5, s[28:31], s56 offen  lds
    buffer_load_dwordx4 v5, s[28:31], s56 offen offset:1024  lds
    ds_read_b128 v[128:131], v1 offset:5152
    s_add_u32 m0, s54, 86688
    v_add_u32_dpp v7, v197, v6 quad_perm:[0,0,0,0] row_mask:0xf bank_mask:0xf
    v_mfma_f32_16x16x32_bf16 v[152:155], v[96:99], v[112:115], v[152:155]
    ds_read_b64_tr_b16 v[104:105], v2 offset:24576
    ds_read_b128 v[132:135], v1 offset:6176
    v_mfma_f32_16x16x32_bf16 v[144:147], v[96:99], v[108:111], v[144:147]
    ds_read_b64_tr_b16 v[106:107], v2 offset:25600
    ds_read_b128 v[136:139], v1 offset:7200
    v_mfma_f32_16x16x32_bf16 v[160:163], v[96:99], v[116:119], v[160:163]
    buffer_load_dwordx4 v7, s[24:27], 0 offen  lds
    s_add_u32 m0, s54, 90816
    v_add_u32_dpp v7, v198, v6 quad_perm:[0,0,0,0] row_mask:0xf bank_mask:0xf
    v_mfma_f32_16x16x32_bf16 v[156:159], v[92:95], v[116:119], v[156:159]
    buffer_load_dwordx4 v7, s[24:27], 0 offen  lds
    v_mfma_f32_16x16x32_bf16 v[164:167], v[92:95], v[120:123], v[164:167]
    v_mfma_f32_16x16x32_bf16 v[168:171], v[96:99], v[120:123], v[168:171]
L_step13:
    s_waitcnt vmcnt(9) lgkmcnt(0)
    v_mfma_f32_16x16x32_bf16 v[140:143], v[100:103], v[124:127], v[140:143]
    s_barrier
    ds_read_b64_tr_b16 v[92:93], v4 offset:32768
    ds_read_b128 v[108:111], v1 offset:8256
    ds_read_b64_tr_b16 v[94:95], v4 offset:33792
    s_add_u32 m0, s55, 16384
    s_mov_b32 s56, 106496
    v_mfma_f32_16x16x32_bf16 v[148:151], v[100:103], v[128:131], v[148:151]
    buffer_load_dwordx4 v5, s[28:31], s56 offen  lds
    ds_read_b128 v[112:115], v1 offset:9280
    v_mfma_f32_16x16x32_bf16 v[152:155], v[104:107], v[128:131], v[152:155]
    ds_read_b64_tr_b16 v[96:97], v2 offset:32768
    ds_read_b128 v[116:119], v1 offset:10304
    v_mfma_f32_16x16x32_bf16 v[144:147], v[104:107], v[124:127], v[144:147]
    ds_read_b64_tr_b16 v[98:99], v2 offset:33792
    ds_read_b128 v[120:123], v1 offset:11328
    v_mfma_f32_16x16x32_bf16 v[160:163], v[104:107], v[132:135], v[160:163]
    v_mfma_f32_16x16x32_bf16 v[156:159], v[100:103], v[132:135], v[156:159]
    buffer_load_dwordx4 v5, s[28:31], s56 offen offset:1024  lds
    s_add_u32 m0, s54, 94944
    v_add_u32_dpp v7, v199, v6 quad_perm:[0,0,0,0] row_mask:0xf bank_mask:0xf
    v_mfma_f32_16x16x32_bf16 v[164:167], v[100:103], v[136:139], v[164:167]
    buffer_load_dwordx4 v7, s[24:27], 0 offen  lds
    v_mfma_f32_16x16x32_bf16 v[168:171], v[104:107], v[136:139], v[168:171]
L_step14:
    s_waitcnt vmcnt(8) lgkmcnt(0)
    v_mfma_f32_16x16x32_bf16 v[140:143], v[92:95], v[108:111], v[140:143]
    s_barrier
    ds_read_b64_tr_b16 v[100:101], v4 offset:0
    ds_read_b128 v[124:127], v1 offset:12384
    ds_read_b64_tr_b16 v[102:103], v4 offset:1024
    s_add_u32 m0, s55, 24576
    s_mov_b32 s56, 114688
    v_add_u32 v9, 16512, v8
    v_xad_u32 v10, v11, 0, v9
    v_mfma_f32_16x16x32_bf16 v[148:151], v[92:95], v[112:115], v[148:151]
    ds_read_b128 a[0:3], v10 offset:0
    ds_read_b128 a[4:7], v10 offset:64
    ds_read_b128 a[8:11], v10 offset:128
    v_mfma_f32_16x16x32_bf16 v[152:155], v[96:99], v[112:115], v[152:155]
    buffer_load_dwordx4 v5, s[28:31], s56 offen  lds
    ds_read_b128 a[12:15], v10 offset:192
    buffer_load_dwordx4 v5, s[28:31], s56 offen offset:1024  lds
    s_add_u32 m0, s54, 0
    v_add_u32_dpp v7, v196, v6 quad_perm:[1,1,1,1] row_mask:0xf bank_mask:0xf
    v_mfma_f32_16x16x32_bf16 v[144:147], v[96:99], v[108:111], v[144:147]
    ds_read_b128 v[128:131], v1 offset:13408
    buffer_load_dwordx4 v7, s[24:27], 0 offen  lds
    ds_read_b64_tr_b16 v[104:105], v2 offset:0
    v_mfma_f32_16x16x32_bf16 v[160:163], v[96:99], v[116:119], v[160:163]
    ds_read_b128 v[132:135], v1 offset:14432
    ds_read_b64_tr_b16 v[106:107], v2 offset:1024
    ds_read_b128 v[136:139], v1 offset:15456
    v_mfma_f32_16x16x32_bf16 v[156:159], v[92:95], v[116:119], v[156:159]
    v_mfma_f32_16x16x32_bf16 v[164:167], v[92:95], v[120:123], v[164:167]
    v_mfma_f32_16x16x32_bf16 v[168:171], v[96:99], v[120:123], v[168:171]
L_step15:
    s_waitcnt vmcnt(8) lgkmcnt(0)
    v_mfma_f32_16x16x32_bf16 v[140:143], v[100:103], v[124:127], v[140:143]
    s_barrier
    ds_read_b64_tr_b16 v[92:93], v4 offset:8192
    ds_read_b128 v[108:111], v1 offset:16512
    ds_read_b64_tr_b16 v[94:95], v4 offset:9216
    s_add_u32 m0, s55, 32768
    s_mov_b32 s56, 122880
    v_xad_u32 v10, v11, 48, v9
    v_mfma_f32_16x16x32_bf16 v[148:151], v[100:103], v[128:131], v[148:151]
    ds_read_b128 a[16:19], v10 offset:256
    ds_read_b128 a[20:23], v10 offset:320
    v_mfma_f32_16x16x32_bf16 v[152:155], v[104:107], v[128:131], v[152:155]
    ds_read_b128 a[24:27], v10 offset:384
    buffer_load_dwordx4 v5, s[28:31], s56 offen  lds
    v_mfma_f32_16x16x32_bf16 v[144:147], v[104:107], v[124:127], v[144:147]
    ds_read_b128 a[28:31], v10 offset:448
    ds_read_b128 v[112:115], v1 offset:17536
    v_mfma_f32_16x16x32_bf16 v[160:163], v[104:107], v[132:135], v[160:163]
    v_mfma_f32_16x16x32_bf16 v[156:159], v[100:103], v[132:135], v[156:159]
    ds_read_b64_tr_b16 v[96:97], v2 offset:8192
    buffer_load_dwordx4 v5, s[28:31], s56 offen offset:1024  lds
    ds_read_b128 v[116:119], v1 offset:18560
    s_add_u32 m0, s54, 4128
    v_add_u32_dpp v7, v197, v6 quad_perm:[1,1,1,1] row_mask:0xf bank_mask:0xf
    v_mfma_f32_16x16x32_bf16 v[32:35], v[172:175], a[0:3], 0
    ds_read_b64_tr_b16 v[98:99], v2 offset:9216
    buffer_load_dwordx4 v7, s[24:27], 0 offen  lds
    ds_read_b128 v[120:123], v1 offset:19584
    v_mfma_f32_16x16x32_bf16 v[164:167], v[100:103], v[136:139], v[164:167]
    v_mfma_f32_16x16x32_bf16 v[168:171], v[104:107], v[136:139], v[168:171]
    v_mfma_f32_16x16x32_bf16 v[36:39], a[0:3], a[0:3], 0
L_step16:
    s_waitcnt vmcnt(7) lgkmcnt(0)
    v_mfma_f32_16x16x32_bf16 v[140:143], v[92:95], v[108:111], v[140:143]
    s_barrier
    ds_read_b64_tr_b16 v[100:101], v4 offset:16384
    ds_read_b128 v[124:127], v1 offset:20640
    s_add_u32 m0, s55, 0
    s_mov_b32 s56, 131072
    v_xad_u32 v10, v11, 32, v9
    v_mfma_f32_16x16x32_bf16 v[148:151], v[92:95], v[112:115], v[148:151]
    ds_read_b128 a[32:35], v10 offset:512
    ds_read_b128 a[36:39], v10 offset:576
    v_mfma_f32_16x16x32_bf16 v[152:155], v[96:99], v[112:115], v[152:155]
    ds_read_b128 a[40:43], v10 offset:640
    buffer_load_dwordx4 v5, s[28:31], s56 offen  lds
    v_mfma_f32_16x16x32_bf16 v[144:147], v[96:99], v[108:111], v[144:147]
    ds_read_b128 a[44:47], v10 offset:704
    ds_read_b64_tr_b16 v[102:103], v4 offset:17408
    v_mfma_f32_16x16x32_bf16 v[28:31], v[176:179], a[4:7], 0
    ds_read_b128 v[128:131], v1 offset:21664
    v_fmac_f32 v44, v32, v61
    v_mfma_f32_16x16x32_bf16 v[160:163], v[96:99], v[116:119], v[160:163]
    ds_read_b64_tr_b16 v[104:105], v2 offset:16384
    buffer_load_dwordx4 v5, s[28:31], s56 offen offset:1024  lds
    ds_read_b128 v[132:135], v1 offset:22688
    s_add_u32 m0, s54, 8256
    v_add_u32_dpp v7, v198, v6 quad_perm:[1,1,1,1] row_mask:0xf bank_mask:0xf
    v_mfma_f32_16x16x32_bf16 v[156:159], v[92:95], v[116:119], v[156:159]
    ds_read_b64_tr_b16 v[106:107], v2 offset:17408
    ds_read_b128 v[136:139], v1 offset:23712
    v_mfma_f32_16x16x32_bf16 v[32:35], a[4:7], a[4:7], 0
    v_fmac_f32 v44, v36, v68
    v_fmac_f32 v44, v37, v69
    v_mfma_f32_16x16x32_bf16 v[164:167], v[92:95], v[120:123], v[164:167]
    buffer_load_dwordx4 v7, s[24:27], 0 offen  lds
    s_add_u32 m0, s54, 12384
    v_add_u32_dpp v7, v199, v6 quad_perm:[1,1,1,1] row_mask:0xf bank_mask:0xf
    v_mfma_f32_16x16x32_bf16 v[168:171], v[96:99], v[120:123], v[168:171]
    buffer_load_dwordx4 v7, s[24:27], 0 offen  lds
    v_fmac_f32 v44, v38, v70
    v_fmac_f32 v44, v39, v71
    v_mfma_f32_16x16x32_bf16 v[36:39], v[180:183], a[8:11], 0
    v_fmac_f32 v45, v28, v61
    v_fmac_f32 v45, v32, v68
L_step17:
    v_fmac_f32 v45, v33, v69
    v_fmac_f32 v45, v34, v70
    v_fmac_f32 v45, v35, v71
    s_waitcnt vmcnt(8) lgkmcnt(0)
    v_mfma_f32_16x16x32_bf16 v[140:143], v[100:103], v[124:127], v[140:143]
    s_barrier
    ds_read_b64_tr_b16 v[92:93], v4 offset:24576
    ds_read_b128 v[108:111], v1 offset:24768
    ds_read_b64_tr_b16 v[94:95], v4 offset:25600
    s_add_u32 m0, s55, 8192
    s_mov_b32 s56, 139264
    v_xad_u32 v10, v11, 16, v9
    v_mfma_f32_16x16x32_bf16 v[148:151], v[100:103], v[128:131], v[148:151]
    ds_read_b128 a[48:51], v10 offset:768
    ds_read_b128 a[52:55], v10 offset:832
    ds_read_b128 a[56:59], v10 offset:896
    v_mfma_f32_16x16x32_bf16 v[152:155], v[104:107], v[128:131], v[152:155]
    buffer_load_dwordx4 v5, s[28:31], s56 offen  lds
    ds_read_b128 a[60:63], v10 offset:960
    buffer_load_dwordx4 v5, s[28:31], s56 offen offset:1024  lds
    v_mfma_f32_16x16x32_bf16 v[144:147], v[104:107], v[124:127], v[144:147]
    ds_read_b128 v[112:115], v1 offset:25792
    ds_read_b64_tr_b16 v[96:97], v2 offset:24576
    ds_read_b128 v[116:119], v1 offset:26816
    v_mfma_f32_16x16x32_bf16 v[160:163], v[104:107], v[132:135], v[160:163]
    v_fmac_f32 v46, v36, v61
    v_mfma_f32_16x16x32_bf16 v[156:159], v[100:103], v[132:135], v[156:159]
    ds_read_b64_tr_b16 v[98:99], v2 offset:25600
    ds_read_b128 v[120:123], v1 offset:27840
    v_mfma_f32_16x16x32_bf16 v[28:31], a[8:11], a[8:11], 0
    v_mfma_f32_16x16x32_bf16 v[164:167], v[100:103], v[136:139], v[164:167]
    v_mfma_f32_16x16x32_bf16 v[168:171], v[104:107], v[136:139], v[168:171]
    v_mfma_f32_16x16x32_bf16 v[32:35], v[184:187], a[12:15], 0
L_step18:
    s_waitcnt vmcnt(7) lgkmcnt(0)
    v_mfma_f32_16x16x32_bf16 v[140:143], v[92:95], v[108:111], v[140:143]
    s_barrier
    ds_read_b64_tr_b16 v[100:101], v4 offset:32768
    ds_read_b128 v[124:127], v1 offset:28896
    s_add_u32 m0, s55, 16384
    s_mov_b32 s56, 147456
    v_mfma_f32_16x16x32_bf16 v[148:151], v[92:95], v[112:115], v[148:151]
    buffer_load_dwordx4 v5, s[28:31], s56 offen  lds
    ds_read_b64_tr_b16 v[102:103], v4 offset:33792
    v_mfma_f32_16x16x32_bf16 v[152:155], v[96:99], v[112:115], v[152:155]
    ds_read_b128 v[128:131], v1 offset:29920
    ds_read_b64_tr_b16 v[104:105], v2 offset:32768
    v_mfma_f32_16x16x32_bf16 v[144:147], v[96:99], v[108:111], v[144:147]
    ds_read_b128 v[132:135], v1 offset:30944
    ds_read_b64_tr_b16 v[106:107], v2 offset:33792
    v_mfma_f32_16x16x32_bf16 v[160:163], v[96:99], v[116:119], v[160:163]
    ds_read_b128 v[136:139], v1 offset:31968
    v_fmac_f32 v46, v28, v68
    v_mfma_f32_16x16x32_bf16 v[156:159], v[92:95], v[116:119], v[156:159]
    buffer_load_dwordx4 v5, s[28:31], s56 offen offset:1024  lds
    s_add_u32 m0, s54, 16512
    v_add_u32_dpp v7, v196, v6 quad_perm:[2,2,2,2] row_mask:0xf bank_mask:0xf
    v_mfma_f32_16x16x32_bf16 v[36:39], a[12:15], a[12:15], 0
    v_fmac_f32 v46, v29, v69
    v_fmac_f32 v46, v30, v70
    v_mfma_f32_16x16x32_bf16 v[164:167], v[92:95], v[120:123], v[164:167]
    buffer_load_dwordx4 v7, s[24:27], 0 offen  lds
    v_fmac_f32 v46, v31, v71
    v_mfma_f32_16x16x32_bf16 v[168:171], v[96:99], v[120:123], v[168:171]
    v_fmac_f32 v47, v32, v61
    v_mfma_f32_16x16x32_bf16 v[28:31], v[172:175], a[16:19], 0
    v_fmac_f32 v47, v36, v68
    v_fmac_f32 v47, v37, v69
L_step19:
    v_fmac_f32 v47, v38, v70
    v_fmac_f32 v47, v39, v71
    s_waitcnt vmcnt(7) lgkmcnt(0)
    v_mfma_f32_16x16x32_bf16 v[140:143], v[100:103], v[124:127], v[140:143]
    s_barrier
    ds_read_b64_tr_b16 v[92:93], v4 offset:0
    ds_read_b128 v[108:111], v1 offset:33024
    s_add_u32 m0, s55, 24576
    s_mov_b32 s56, 155648
    v_mfma_f32_16x16x32_bf16 v[148:151], v[100:103], v[128:131], v[148:151]
    buffer_load_dwordx4 v5, s[28:31], s56 offen  lds
    ds_read_b64_tr_b16 v[94:95], v4 offset:1024
    v_mfma_f32_16x16x32_bf16 v[152:155], v[104:107], v[128:131], v[152:155]
    ds_read_b128 v[112:115], v1 offset:34048
    ds_read_b64_tr_b16 v[96:97], v2 offset:0
    v_mfma_f32_16x16x32_bf16 v[144:147], v[104:107], v[124:127], v[144:147]
    ds_read_b128 v[116:119], v1 offset:35072
    ds_read_b64_tr_b16 v[98:99], v2 offset:1024
    v_mfma_f32_16x16x32_bf16 v[160:163], v[104:107], v[132:135], v[160:163]
    ds_read_b128 v[120:123], v1 offset:36096
    v_fmac_f32 v48, v29, v61
    v_mfma_f32_16x16x32_bf16 v[156:159], v[100:103], v[132:135], v[156:159]
    buffer_load_dwordx4 v5, s[28:31], s56 offen offset:1024  lds
    s_add_u32 m0, s54, 20640
    v_add_u32_dpp v7, v197, v6 quad_perm:[2,2,2,2] row_mask:0xf bank_mask:0xf
    v_mfma_f32_16x16x32_bf16 v[32:35], a[16:19], a[16:19], 0
    v_mfma_f32_16x16x32_bf16 v[164:167], v[100:103], v[136:139], v[164:167]
    buffer_load_dwordx4 v7, s[24:27], 0 offen  lds
    v_mfma_f32_16x16x32_bf16 v[168:171], v[104:107], v[136:139], v[168:171]
    v_mfma_f32_16x16x32_bf16 v[36:39], v[176:179], a[20:23], 0
L_step20:
    s_waitcnt vmcnt(6) lgkmcnt(0)
    v_mfma_f32_16x16x32_bf16 v[140:143], v[92:95], v[108:111], v[140:143]
    s_barrier
    ds_read_b64_tr_b16 v[100:101], v4 offset:8192
    ds_read_b128 v[124:127], v1 offset:37152
    s_add_u32 m0, s55, 32768
    s_mov_b32 s56, 163840
    v_mfma_f32_16x16x32_bf16 v[148:151], v[92:95], v[112:115], v[148:151]
    buffer_load_dwordx4 v5, s[28:31], s56 offen  lds
    ds_read_b64_tr_b16 v[102:103], v4 offset:9216
    v_mfma_f32_16x16x32_bf16 v[152:155], v[96:99], v[112:115], v[152:155]
    ds_read_b128 v[128:131], v1 offset:38176
    ds_read_b64_tr_b16 v[104:105], v2 offset:8192
    v_mfma_f32_16x16x32_bf16 v[144:147], v[96:99], v[108:111], v[144:147]
    ds_read_b128 v[132:135], v1 offset:39200
    ds_read_b64_tr_b16 v[106:107], v2 offset:9216
    v_mfma_f32_16x16x32_bf16 v[28:31], a[20:23], a[20:23], 0
    ds_read_b128 v[136:139], v1 offset:40224
    v_fmac_f32 v48, v32, v68
    v_mfma_f32_16x16x32_bf16 v[160:163], v[96:99], v[116:119], v[160:163]
    buffer_load_dwordx4 v5, s[28:31], s56 offen offset:1024  lds
    s_add_u32 m0, s54, 24768
    v_add_u32_dpp v7, v198, v6 quad_perm:[2,2,2,2] row_mask:0xf bank_mask:0xf
    v_mfma_f32_16x16x32_bf16 v[156:159], v[92:95], v[116:119], v[156:159]
    v_fmac_f32 v48, v33, v69
    v_fmac_f32 v48, v34, v70
    v_fmac_f32 v48, v35, v71
    v_mfma_f32_16x16x32_bf16 v[32:35], v[180:183], a[24:27], 0
    ds_read_b32 v60, v13 offset:272
    buffer_load_dwordx4 v7, s[24:27], 0 offen  lds
    s_add_u32 m0, s54, 28896
    v_add_u32_dpp v7, v199, v6 quad_perm:[2,2,2,2] row_mask:0xf bank_mask:0xf
    v_mfma_f32_16x16x32_bf16 v[164:167], v[92:95], v[120:123], v[164:167]
    buffer_load_dwordx4 v7, s[24:27], 0 offen  lds
    v_add_u32 v190, L_step28-L_pc, v189
    v_mfma_f32_16x16x32_bf16 v[168:171], v[96:99], v[120:123], v[168:171]
    global_load_dword v190, v190, s[62:63]
    v_fmac_f32 v49, v37, v61
    v_mfma_f32_16x16x32_bf16 v[36:39], a[24:27], a[24:27], 0
    v_fmac_f32 v49, v28, v68
    v_fmac_f32 v49, v29, v69
L_step21:
    v_fmac_f32 v49, v30, v70
    v_fmac_f32 v49, v31, v71
    v_fmac_f32 v50, v33, v61
    s_waitcnt vmcnt(9) lgkmcnt(1)
    v_mfma_f32_16x16x32_bf16 v[140:143], v[100:103], v[124:127], v[140:143]
    s_barrier
    ds_read_b64_tr_b16 v[92:93], v4 offset:16384
    ds_read_b128 v[108:111], v1 offset:41280
    s_add_u32 m0, s55, 0
    s_mov_b32 s56, 172032
    v_mfma_f32_16x16x32_bf16 v[148:151], v[100:103], v[128:131], v[148:151]
    buffer_load_dwordx4 v5, s[28:31], s56 offen  lds
    ds_read_b64_tr_b16 v[94:95], v4 offset:17408
    v_mfma_f32_16x16x32_bf16 v[152:155], v[104:107], v[128:131], v[152:155]
    ds_read_b128 v[112:115], v1 offset:42304
    ds_read_b64_tr_b16 v[96:97], v2 offset:16384
    v_mfma_f32_16x16x32_bf16 v[144:147], v[104:107], v[124:127], v[144:147]
    ds_read_b128 v[116:119], v1 offset:43328
    ds_read_b64_tr_b16 v[98:99], v2 offset:17408
    v_mfma_f32_16x16x32_bf16 v[160:163], v[104:107], v[132:135], v[160:163]
    ds_read_b128 v[120:123], v1 offset:44352
    v_fmac_f32 v50, v36, v68
    v_mfma_f32_16x16x32_bf16 v[156:159], v[100:103], v[132:135], v[156:159]
    buffer_load_dwordx4 v5, s[28:31], s56 offen offset:1024  lds
    s_add_u32 m0, s54, 33024
    v_add_u32_dpp v7, v196, v6 quad_perm:[3,3,3,3] row_mask:0xf bank_mask:0xf
    v_mfma_f32_16x16x32_bf16 v[28:31], v[184:187], a[28:31], 0
    v_fmac_f32 v50, v37, v69
    v_fmac_f32 v50, v38, v70
    v_mfma_f32_16x16x32_bf16 v[164:167], v[100:103], v[136:139], v[164:167]
    buffer_load_dwordx4 v7, s[24:27], 0 offen  lds
    v_fmac_f32 v50, v39, v71
    v_mfma_f32_16x16x32_bf16 v[168:171], v[104:107], v[136:139], v[168:171]
    v_mfma_f32_16x16x32_bf16 v[32:35], a[28:31], a[28:31], 0
L_step22:
    s_waitcnt vmcnt(9) lgkmcnt(0)
    v_mfma_f32_16x16x32_bf16 v[140:143], v[92:95], v[108:111], v[140:143]
    s_barrier
    ds_read_b64_tr_b16 v[100:101], v4 offset:24576
    ds_read_b128 v[124:127], v1 offset:45408
    s_add_u32 m0, s55, 8192
    s_mov_b32 s56, 180224
    v_mfma_f32_16x16x32_bf16 v[148:151], v[92:95], v[112:115], v[148:151]
    buffer_load_dwordx4 v5, s[28:31], s56 offen  lds
    ds_read_b64_tr_b16 v[102:103], v4 offset:25600
    v_mfma_f32_16x16x32_bf16 v[152:155], v[96:99], v[112:115], v[152:155]
    ds_read_b128 v[128:131], v1 offset:46432
    ds_read_b64_tr_b16 v[104:105], v2 offset:24576
    v_mfma_f32_16x16x32_bf16 v[144:147], v[96:99], v[108:111], v[144:147]
    ds_read_b128 v[132:135], v1 offset:47456
    ds_read_b64_tr_b16 v[106:107], v2 offset:25600
    v_mfma_f32_16x16x32_bf16 v[160:163], v[96:99], v[116:119], v[160:163]
    ds_read_b128 v[136:139], v1 offset:48480
    v_fmac_f32 v51, v29, v61
    v_mfma_f32_16x16x32_bf16 v[156:159], v[92:95], v[116:119], v[156:159]
    buffer_load_dwordx4 v5, s[28:31], s56 offen offset:1024  lds
    s_add_u32 m0, s54, 37152
    v_add_u32_dpp v7, v197, v6 quad_perm:[3,3,3,3] row_mask:0xf bank_mask:0xf
    v_mfma_f32_16x16x32_bf16 v[36:39], v[172:175], a[32:35], 0
    ds_read_b128 v[72:75], v12 offset:2048
    v_fmac_f32 v51, v32, v68
    v_mfma_f32_16x16x32_bf16 v[164:167], v[92:95], v[120:123], v[164:167]
    buffer_load_dwordx4 v7, s[24:27], 0 offen  lds
    v_fmac_f32 v51, v33, v69
    v_mfma_f32_16x16x32_bf16 v[168:171], v[96:99], v[120:123], v[168:171]
    v_fmac_f32 v51, v34, v70
    v_fmac_f32 v51, v35, v71
    v_mfma_f32_16x16x32_bf16 v[28:31], a[32:35], a[32:35], 0
    v_fmac_f32 v52, v38, v61
L_step23:
    s_waitcnt vmcnt(9) lgkmcnt(1)
    v_mfma_f32_16x16x32_bf16 v[140:143], v[100:103], v[124:127], v[140:143]
    s_barrier
    ds_read_b64_tr_b16 v[92:93], v4 offset:32768
    ds_read_b128 v[108:111], v0 offset:0
    s_add_u32 m0, s55, 16384
    s_mov_b32 s56, 188416
    v_mfma_f32_16x16x32_bf16 v[148:151], v[100:103], v[128:131], v[148:151]
    buffer_load_dwordx4 v5, s[28:31], s56 offen  lds
    ds_read_b64_tr_b16 v[94:95], v4 offset:33792
    v_mfma_f32_16x16x32_bf16 v[152:155], v[104:107], v[128:131], v[152:155]
    ds_read_b128 v[112:115], v0 offset:1024
    ds_read_b64_tr_b16 v[96:97], v2 offset:32768
    v_mfma_f32_16x16x32_bf16 v[144:147], v[104:107], v[124:127], v[144:147]
    ds_read_b128 v[116:119], v0 offset:2048
    v_fmac_f32 v52, v28, v68
    v_mfma_f32_16x16x32_bf16 v[32:35], v[176:179], a[36:39], 0
    ds_read_b64_tr_b16 v[98:99], v2 offset:33792
    v_fmac_f32 v52, v29, v69
    v_mfma_f32_16x16x32_bf16 v[160:163], v[104:107], v[132:135], v[160:163]
    buffer_load_dwordx4 v5, s[28:31], s56 offen offset:1024  lds
    s_add_u32 m0, s54, 41280
    v_add_u32_dpp v7, v198, v6 quad_perm:[3,3,3,3] row_mask:0xf bank_mask:0xf
    v_mfma_f32_16x16x32_bf16 v[156:159], v[100:103], v[132:135], v[156:159]
    ds_read_b128 v[120:123], v0 offset:3072
    v_fmac_f32 v52, v30, v70
    v_mfma_f32_16x16x32_bf16 v[36:39], a[36:39], a[36:39], 0
    v_fmac_f32 v52, v31, v71
    v_fmac_f32 v53, v34, v61
    v_mfma_f32_16x16x32_bf16 v[164:167], v[100:103], v[136:139], v[164:167]
    buffer_load_dwordx4 v7, s[24:27], 0 offen  lds
    v_mfma_f32_16x16x32_bf16 v[168:171], v[104:107], v[136:139], v[168:171]
    v_mfma_f32_16x16x32_bf16 v[28:31], v[180:183], a[40:43], 0
L_step24:
    s_waitcnt vmcnt(7) lgkmcnt(0)
    v_mfma_f32_16x16x32_bf16 v[140:143], v[92:95], v[108:111], v[140:143]
    s_barrier
    ds_read_b64_tr_b16 v[100:101], v4 offset:0
    ds_read_b128 v[124:127], v0 offset:4128
    s_add_u32 m0, s55, 24576
    s_mov_b32 s56, 196608
    v_mfma_f32_16x16x32_bf16 v[148:151], v[92:95], v[112:115], v[148:151]
    buffer_load_dwordx4 v5, s[28:31], s56 offen  lds
    ds_read_b64_tr_b16 v[102:103], v4 offset:1024
    v_mfma_f32_16x16x32_bf16 v[152:155], v[96:99], v[112:115], v[152:155]
    ds_read_b128 v[128:131], v0 offset:5152
    ds_read_b64_tr_b16 v[104:105], v2 offset:0
    v_mfma_f32_16x16x32_bf16 v[144:147], v[96:99], v[108:111], v[144:147]
    ds_read_b128 v[132:135], v0 offset:6176
    ds_read_b64_tr_b16 v[106:107], v2 offset:1024
    v_mfma_f32_16x16x32_bf16 v[160:163], v[96:99], v[116:119], v[160:163]
    ds_read_b128 v[136:139], v0 offset:7200
    v_fmac_f32 v53, v36, v68
    v_mfma_f32_16x16x32_bf16 v[156:159], v[92:95], v[116:119], v[156:159]
    buffer_load_dwordx4 v5, s[28:31], s56 offen offset:1024  lds
    s_add_u32 m0, s54, 45408
    v_add_u32_dpp v7, v199, v6 quad_perm:[3,3,3,3] row_mask:0xf bank_mask:0xf
    v_mfma_f32_16x16x32_bf16 v[32:35], a[40:43], a[40:43], 0
    v_fmac_f32 v53, v37, v69
    v_fmac_f32 v53, v38, v70
    v_mfma_f32_16x16x32_bf16 v[164:167], v[92:95], v[120:123], v[164:167]
    buffer_load_dwordx4 v7, s[24:27], 0 offen  lds
    s_add_u32 m0, s54, 49536
    v_add_u32_dpp v7, v200, v6 quad_perm:[0,0,0,0] row_mask:0xf bank_mask:0xf
    v_mfma_f32_16x16x32_bf16 v[168:171], v[96:99], v[120:123], v[168:171]
    buffer_load_dwordx4 v7, s[24:27], 0 offen  lds
    v_fmac_f32 v53, v39, v71
    v_mfma_f32_16x16x32_bf16 v[36:39], v[184:187], a[44:47], 0
    v_fmac_f32 v54, v30, v61
    v_fmac_f32 v54, v32, v68
L_step25:
    v_fmac_f32 v54, v33, v69
    v_fmac_f32 v54, v34, v70
    v_fmac_f32 v54, v35, v71
    s_waitcnt vmcnt(8) lgkmcnt(0)
    v_mfma_f32_16x16x32_bf16 v[140:143], v[100:103], v[124:127], v[140:143]
    s_barrier
    ds_read_b64_tr_b16 v[92:93], v4 offset:8192
    ds_read_b128 v[108:111], v0 offset:8256
    s_add_u32 m0, s55, 32768
    s_mov_b32 s56, 204800
    v_mfma_f32_16x16x32_bf16 v[148:151], v[100:103], v[128:131], v[148:151]
    buffer_load_dwordx4 v5, s[28:31], s56 offen  lds
    ds_read_b64_tr_b16 v[94:95], v4 offset:9216
    v_mfma_f32_16x16x32_bf16 v[152:155], v[104:107], v[128:131], v[152:155]
    ds_read_b128 v[112:115], v0 offset:9280
    ds_read_b64_tr_b16 v[96:97], v2 offset:8192
    v_mfma_f32_16x16x32_bf16 v[144:147], v[104:107], v[124:127], v[144:147]
    ds_read_b128 v[116:119], v0 offset:10304
    ds_read_b64_tr_b16 v[98:99], v2 offset:9216
    v_mfma_f32_16x16x32_bf16 v[160:163], v[104:107], v[132:135], v[160:163]
    ds_read_b128 v[120:123], v0 offset:11328
    v_fmac_f32 v55, v38, v61
    v_mfma_f32_16x16x32_bf16 v[156:159], v[100:103], v[132:135], v[156:159]
    buffer_load_dwordx4 v5, s[28:31], s56 offen offset:1024  lds
    s_add_u32 m0, s54, 53664
    v_add_u32_dpp v7, v201, v6 quad_perm:[0,0,0,0] row_mask:0xf bank_mask:0xf
    v_mfma_f32_16x16x32_bf16 v[28:31], a[44:47], a[44:47], 0
    v_mfma_f32_16x16x32_bf16 v[164:167], v[100:103], v[136:139], v[164:167]
    buffer_load_dwordx4 v7, s[24:27], 0 offen  lds
    v_mfma_f32_16x16x32_bf16 v[168:171], v[104:107], v[136:139], v[168:171]
    v_mfma_f32_16x16x32_bf16 v[32:35], v[172:175], a[48:51], 0
L_step26:
    s_waitcnt vmcnt(8) lgkmcnt(0)
    v_mfma_f32_16x16x32_bf16 v[140:143], v[92:95], v[108:111], v[140:143]
    s_barrier
    ds_read_b64_tr_b16 v[100:101], v4 offset:16384
    ds_read_b128 v[124:127], v0 offset:12384
    s_add_u32 m0, s55, 0
    s_mov_b32 s56, 212992
    v_mfma_f32_16x16x32_bf16 v[148:151], v[92:95], v[112:115], v[148:151]
    buffer_load_dwordx4 v5, s[28:31], s56 offen  lds
    ds_read_b64_tr_b16 v[102:103], v4 offset:17408
    v_mfma_f32_16x16x32_bf16 v[152:155], v[96:99], v[112:115], v[152:155]
    ds_read_b128 v[128:131], v0 offset:13408
    ds_read_b64_tr_b16 v[104:105], v2 offset:16384
    v_mfma_f32_16x16x32_bf16 v[144:147], v[96:99], v[108:111], v[144:147]
    ds_read_b128 v[132:135], v0 offset:14432
    ds_read_b64_tr_b16 v[106:107], v2 offset:17408
    v_mfma_f32_16x16x32_bf16 v[160:163], v[96:99], v[116:119], v[160:163]
    ds_read_b128 v[136:139], v0 offset:15456
    v_fmac_f32 v55, v28, v68
    v_mfma_f32_16x16x32_bf16 v[156:159], v[92:95], v[116:119], v[156:159]
    buffer_load_dwordx4 v5, s[28:31], s56 offen offset:1024  lds
    s_add_u32 m0, s54, 57792
    v_add_u32_dpp v7, v202, v6 quad_perm:[0,0,0,0] row_mask:0xf bank_mask:0xf
    v_mfma_f32_16x16x32_bf16 v[36:39], a[48:51], a[48:51], 0
    v_fmac_f32 v55, v29, v69
    v_fmac_f32 v55, v30, v70
    v_mfma_f32_16x16x32_bf16 v[164:167], v[92:95], v[120:123], v[164:167]
    buffer_load_dwordx4 v7, s[24:27], 0 offen  lds
    v_fmac_f32 v55, v31, v71
    v_mfma_f32_16x16x32_bf16 v[168:171], v[96:99], v[120:123], v[168:171]
    v_fmac_f32 v56, v35, v61
    v_mfma_f32_16x16x32_bf16 v[28:31], v[176:179], a[52:55], 0
    v_fmac_f32 v56, v36, v68
    v_fmac_f32 v56, v37, v69
L_step27:
    v_fmac_f32 v56, v38, v70
    v_fmac_f32 v56, v39, v71
    s_waitcnt vmcnt(8) lgkmcnt(0)
    v_mfma_f32_16x16x32_bf16 v[140:143], v[100:103], v[124:127], v[140:143]
    s_barrier
    ds_read_b64_tr_b16 v[92:93], v4 offset:24576
    ds_read_b128 v[108:111], v0 offset:16512
    s_add_u32 m0, s55, 8192
    s_mov_b32 s56, 221184
    v_mfma_f32_16x16x32_bf16 v[148:151], v[100:103], v[128:131], v[148:151]
    buffer_load_dwordx4 v5, s[28:31], s56 offen  lds
    ds_read_b64_tr_b16 v[94:95], v4 offset:25600
    v_mfma_f32_16x16x32_bf16 v[152:155], v[104:107], v[128:131], v[152:155]
    ds_read_b128 v[112:115], v0 offset:17536
    ds_read_b64_tr_b16 v[96:97], v2 offset:24576
    v_mfma_f32_16x16x32_bf16 v[144:147], v[104:107], v[124:127], v[144:147]
    ds_read_b128 v[116:119], v0 offset:18560
    v_fmac_f32 v57, v31, v61
    v_mfma_f32_16x16x32_bf16 v[32:35], a[52:55], a[52:55], 0
    ds_read_b64_tr_b16 v[98:99], v2 offset:25600
    v_mfma_f32_16x16x32_bf16 v[160:163], v[104:107], v[132:135], v[160:163]
    buffer_load_dwordx4 v5, s[28:31], s56 offen offset:1024  lds
    s_add_u32 m0, s54, 61920
    v_add_u32_dpp v7, v203, v6 quad_perm:[0,0,0,0] row_mask:0xf bank_mask:0xf
    v_mfma_f32_16x16x32_bf16 v[156:159], v[100:103], v[132:135], v[156:159]
    ds_read_b128 v[120:123], v0 offset:19584
    v_mfma_f32_16x16x32_bf16 v[36:39], v[180:183], a[56:59], 0
    v_fmac_f32 v57, v32, v68
    v_fmac_f32 v57, v33, v69
    v_mfma_f32_16x16x32_bf16 v[164:167], v[100:103], v[136:139], v[164:167]
    buffer_load_dwordx4 v7, s[24:27], 0 offen  lds
    v_fmac_f32 v57, v34, v70
    v_mfma_f32_16x16x32_bf16 v[168:171], v[104:107], v[136:139], v[168:171]
    v_fmac_f32 v57, v35, v71
    v_mfma_f32_16x16x32_bf16 v[28:31], a[56:59], a[56:59], 0
    v_fmac_f32 v58, v39, v61
L_step28:
    s_waitcnt vmcnt(7) lgkmcnt(0)
    v_mfma_f32_16x16x32_bf16 v[140:143], v[92:95], v[108:111], v[140:143]
    s_barrier
    ds_read_b64_tr_b16 v[100:101], v4 offset:32768
    ds_read_b128 v[124:127], v0 offset:20640
    ds_read_b64_tr_b16 v[102:103], v4 offset:33792
    s_add_u32 m0, s55, 16384
    s_mov_b32 s56, 229376
    s_mov_b32 vcc_lo, 0xfff0fff0
    s_mov_b32 vcc_hi, 0xfff0fff0
    v_add_u32 v9, 82560, v8
    v_subrev_u32 v17, 16512, v8
    v_cndmask_b32 v9, v9, v17, vcc
    v_xad_u32 v10, v11, 0, v9
    v_mfma_f32_16x16x32_bf16 v[148:151], v[92:95], v[112:115], v[148:151]
    ds_read_b128 a[64:67], v10 offset:0
    ds_read_b128 a[68:71], v10 offset:64
    ds_read_b128 a[72:75], v10 offset:128
    v_mfma_f32_16x16x32_bf16 v[152:155], v[96:99], v[112:115], v[152:155]
    buffer_load_dwordx4 v5, s[28:31], s56 offen  lds
    ds_read_b128 a[76:79], v10 offset:192
    v_mfma_f32_16x16x32_bf16 v[144:147], v[96:99], v[108:111], v[144:147]
    ds_read_b128 v[128:131], v0 offset:21664
    v_fmac_f32 v58, v28, v68
    v_mfma_f32_16x16x32_bf16 v[160:163], v[96:99], v[116:119], v[160:163]
    ds_read_b64_tr_b16 v[104:105], v2 offset:32768
    buffer_load_dwordx4 v5, s[28:31], s56 offen offset:1024  lds
    ds_read_b128 v[132:135], v0 offset:22688
    s_add_u32 m0, s54, 66048
    v_add_u32_dpp v7, v200, v6 quad_perm:[1,1,1,1] row_mask:0xf bank_mask:0xf
    v_mfma_f32_16x16x32_bf16 v[156:159], v[92:95], v[116:119], v[156:159]
    ds_read_b64_tr_b16 v[106:107], v2 offset:33792
    ds_read_b128 v[136:139], v0 offset:23712
    v_mfma_f32_16x16x32_bf16 v[32:35], v[184:187], a[60:63], 0
    v_fmac_f32 v58, v29, v69
    v_fmac_f32 v58, v30, v70
    v_mfma_f32_16x16x32_bf16 v[164:167], v[92:95], v[120:123], v[164:167]
    buffer_load_dwordx4 v7, s[24:27], 0 offen  lds
    s_add_u32 m0, s54, 70176
    v_add_u32_dpp v7, v201, v6 quad_perm:[1,1,1,1] row_mask:0xf bank_mask:0xf
    v_mfma_f32_16x16x32_bf16 v[168:171], v[96:99], v[120:123], v[168:171]
    buffer_load_dwordx4 v7, s[24:27], 0 offen  lds
    v_fmac_f32 v58, v31, v71
    v_mfma_f32_16x16x32_bf16 v[36:39], a[60:63], a[60:63], 0
    v_fmac_f32 v59, v35, v61
L_step29:
    s_waitcnt vmcnt(8) lgkmcnt(0)
    v_mfma_f32_16x16x32_bf16 v[140:143], v[100:103], v[124:127], v[140:143]
    s_barrier
    ds_read_b64_tr_b16 v[92:93], v4 offset:0
    ds_read_b128 v[108:111], v0 offset:24768
    s_add_u32 m0, s55, 24576
    s_mov_b32 s56, 237568
    v_xad_u32 v10, v11, 48, v9
    v_mfma_f32_16x16x32_bf16 v[148:151], v[100:103], v[128:131], v[148:151]
    ds_read_b128 a[80:83], v10 offset:256
    ds_read_b128 a[84:87], v10 offset:320
    v_mfma_f32_16x16x32_bf16 v[152:155], v[104:107], v[128:131], v[152:155]
    ds_read_b128 a[88:91], v10 offset:384
    buffer_load_dwordx4 v5, s[28:31], s56 offen  lds
    v_mfma_f32_16x16x32_bf16 v[144:147], v[104:107], v[124:127], v[144:147]
    ds_read_b128 a[92:95], v10 offset:448
    ds_read_b64_tr_b16 v[94:95], v4 offset:1024
    v_mfma_f32_16x16x32_bf16 v[28:31], v[172:175], a[64:67], 0
    ds_read_b128 v[112:115], v0 offset:25792
    v_fmac_f32 v59, v36, v68
    v_mfma_f32_16x16x32_bf16 v[160:163], v[104:107], v[132:135], v[160:163]
    ds_read_b64_tr_b16 v[96:97], v2 offset:0
    ds_read_b128 v[116:119], v0 offset:26816
    v_mfma_f32_16x16x32_bf16 v[156:159], v[100:103], v[132:135], v[156:159]
    buffer_load_dwordx4 v5, s[28:31], s56 offen offset:1024  lds
    ds_read_b64_tr_b16 v[98:99], v2 offset:1024
    s_add_u32 m0, s54, 74304
    v_add_u32_dpp v7, v202, v6 quad_perm:[1,1,1,1] row_mask:0xf bank_mask:0xf
    v_mfma_f32_16x16x32_bf16 v[32:35], a[64:67], a[64:67], 0
    ds_read_b128 v[120:123], v0 offset:27840
    v_fmac_f32 v59, v37, v69
    v_mfma_f32_16x16x32_bf16 v[164:167], v[100:103], v[136:139], v[164:167]
    v_fmac_f32 v59, v38, v70
    v_fmac_f32 v59, v39, v71
    v_mfma_f32_16x16x32_bf16 v[36:39], a[0:3], a[64:67], 0
    ds_read_b128 v[68:71], v12 offset:1024
    buffer_load_dwordx4 v7, s[24:27], 0 offen  lds
    v_mfma_f32_16x16x32_bf16 v[168:171], v[104:107], v[136:139], v[168:171]
    v_fmac_f32 v44, v28, v60
    v_fmac_f32 v44, v32, v72
    v_mfma_f32_16x16x32_bf16 v[28:31], v[176:179], a[68:71], 0
    v_fmac_f32 v44, v33, v73
    v_fmac_f32 v44, v34, v74
L_step30:
    v_fmac_f32 v44, v35, v75
    s_waitcnt lgkmcnt(0)
    v_fmac_f32 v44, v36, v68
    v_fmac_f32 v44, v37, v69
    v_fmac_f32 v44, v38, v70
    v_fmac_f32 v44, v39, v71
    v_fmac_f32 v45, v28, v60
    s_waitcnt vmcnt(8)
    v_mfma_f32_16x16x32_bf16 v[140:143], v[92:95], v[108:111], v[140:143]
    s_barrier
    ds_read_b64_tr_b16 v[100:101], v4 offset:8192
    ds_read_b128 v[124:127], v0 offset:28896
    s_add_u32 m0, s55, 32768
    s_mov_b32 s56, 245760
    v_xad_u32 v10, v11, 32, v9
    v_mfma_f32_16x16x32_bf16 v[148:151], v[92:95], v[112:115], v[148:151]
    ds_read_b128 a[96:99], v10 offset:512
    ds_read_b128 a[100:103], v10 offset:576
    v_mfma_f32_16x16x32_bf16 v[152:155], v[96:99], v[112:115], v[152:155]
    ds_read_b128 a[104:107], v10 offset:640
    buffer_load_dwordx4 v5, s[28:31], s56 offen  lds
    v_mfma_f32_16x16x32_bf16 v[144:147], v[96:99], v[108:111], v[144:147]
    ds_read_b128 a[108:111], v10 offset:704
    ds_read_b64_tr_b16 v[102:103], v4 offset:9216
    v_mfma_f32_16x16x32_bf16 v[32:35], a[68:71], a[68:71], 0
    ds_read_b128 v[128:131], v0 offset:29920
    v_mfma_f32_16x16x32_bf16 v[160:163], v[96:99], v[116:119], v[160:163]
    ds_read_b64_tr_b16 v[104:105], v2 offset:8192
    buffer_load_dwordx4 v5, s[28:31], s56 offen offset:1024  lds
    ds_read_b128 v[132:135], v0 offset:30944
    s_add_u32 m0, s54, 78432
    v_add_u32_dpp v7, v203, v6 quad_perm:[1,1,1,1] row_mask:0xf bank_mask:0xf
    v_mfma_f32_16x16x32_bf16 v[156:159], v[92:95], v[116:119], v[156:159]
    ds_read_b64_tr_b16 v[106:107], v2 offset:9216
    ds_read_b128 v[136:139], v0 offset:31968
    v_mfma_f32_16x16x32_bf16 v[36:39], a[4:7], a[68:71], 0
    v_fmac_f32 v45, v32, v72
    v_fmac_f32 v45, v33, v73
    v_mfma_f32_16x16x32_bf16 v[164:167], v[92:95], v[120:123], v[164:167]
    buffer_load_dwordx4 v7, s[24:27], 0 offen  lds
    v_add_u32 v190, L_step38-L_pc, v189
    v_mfma_f32_16x16x32_bf16 v[168:171], v[96:99], v[120:123], v[168:171]
    global_load_dword v190, v190, s[62:63]
    v_fmac_f32 v45, v34, v74
    v_mfma_f32_16x16x32_bf16 v[28:31], v[180:183], a[72:75], 0
    v_fmac_f32 v45, v35, v75
    v_fmac_f32 v45, v36, v68
L_step31:
    s_waitcnt vmcnt(9) lgkmcnt(0)
    v_mfma_f32_16x16x32_bf16 v[140:143], v[100:103], v[124:127], v[140:143]
    s_barrier
    ds_read_b64_tr_b16 v[92:93], v4 offset:16384
    ds_read_b128 v[108:111], v0 offset:33024
    s_add_u32 m0, s55, 0
    s_mov_b32 s56, 253952
    v_xad_u32 v10, v11, 16, v9
    v_mfma_f32_16x16x32_bf16 v[148:151], v[100:103], v[128:131], v[148:151]
    ds_read_b128 a[112:115], v10 offset:768
    ds_read_b128 a[116:119], v10 offset:832
    v_mfma_f32_16x16x32_bf16 v[152:155], v[104:107], v[128:131], v[152:155]
    ds_read_b128 a[120:123], v10 offset:896
    buffer_load_dwordx4 v5, s[28:31], s56 offen  lds
    v_mfma_f32_16x16x32_bf16 v[144:147], v[104:107], v[124:127], v[144:147]
    ds_read_b128 a[124:127], v10 offset:960
    ds_read_b64_tr_b16 v[94:95], v4 offset:17408
    v_mfma_f32_16x16x32_bf16 v[32:35], a[72:75], a[72:75], 0
    ds_read_b128 v[112:115], v0 offset:34048
    v_fmac_f32 v45, v37, v69
    v_mfma_f32_16x16x32_bf16 v[160:163], v[104:107], v[132:135], v[160:163]
    ds_read_b64_tr_b16 v[96:97], v2 offset:16384
    ds_read_b128 v[116:119], v0 offset:35072
    v_mfma_f32_16x16x32_bf16 v[156:159], v[100:103], v[132:135], v[156:159]
    buffer_load_dwordx4 v5, s[28:31], s56 offen offset:1024  lds
    v_fmac_f32 v45, v38, v70
    v_fmac_f32 v45, v39, v71
    v_mfma_f32_16x16x32_bf16 v[36:39], a[8:11], a[72:75], 0
    ds_read_b64_tr_b16 v[98:99], v2 offset:17408
    v_fmac_f32 v46, v28, v60
    v_mfma_f32_16x16x32_bf16 v[164:167], v[100:103], v[136:139], v[164:167]
    ds_read_b128 v[120:123], v0 offset:36096
    v_fmac_f32 v46, v32, v72
    v_mfma_f32_16x16x32_bf16 v[28:31], v[184:187], a[76:79], 0
    v_fmac_f32 v46, v33, v73
    v_fmac_f32 v46, v34, v74
    v_mfma_f32_16x16x32_bf16 v[168:171], v[104:107], v[136:139], v[168:171]
    v_fmac_f32 v46, v35, v75
    v_fmac_f32 v46, v36, v68
    v_mfma_f32_16x16x32_bf16 v[32:35], a[76:79], a[76:79], 0
    v_fmac_f32 v46, v37, v69
    v_fmac_f32 v46, v38, v70
L_step32:
    s_waitcnt vmcnt(7) lgkmcnt(0)
    v_mfma_f32_16x16x32_bf16 v[140:143], v[92:95], v[108:111], v[140:143]
    s_barrier
    ds_read_b64_tr_b16 v[100:101], v4 offset:24576
    ds_read_b128 v[124:127], v0 offset:37152
    s_add_u32 m0, s55, 8192
    s_mov_b32 s56, 262144
    v_mfma_f32_16x16x32_bf16 v[148:151], v[92:95], v[112:115], v[148:151]
    buffer_load_dwordx4 v5, s[28:31], s56 offen  lds
    ds_read_b64_tr_b16 v[102:103], v4 offset:25600
    v_mfma_f32_16x16x32_bf16 v[152:155], v[96:99], v[112:115], v[152:155]
    ds_read_b128 v[128:131], v0 offset:38176
    ds_read_b64_tr_b16 v[104:105], v2 offset:24576
    v_mfma_f32_16x16x32_bf16 v[144:147], v[96:99], v[108:111], v[144:147]
    ds_read_b128 v[132:135], v0 offset:39200
    v_fmac_f32 v46, v39, v71
    v_mfma_f32_16x16x32_bf16 v[36:39], a[12:15], a[76:79], 0
    ds_read_b64_tr_b16 v[106:107], v2 offset:25600
    v_fmac_f32 v47, v28, v60
    v_mfma_f32_16x16x32_bf16 v[160:163], v[96:99], v[116:119], v[160:163]
    buffer_load_dwordx4 v5, s[28:31], s56 offen offset:1024  lds
    s_add_u32 m0, s54, 82560
    v_add_u32_dpp v7, v200, v6 quad_perm:[2,2,2,2] row_mask:0xf bank_mask:0xf
    v_mfma_f32_16x16x32_bf16 v[156:159], v[92:95], v[116:119], v[156:159]
    ds_read_b128 v[136:139], v0 offset:40224
    v_fmac_f32 v47, v32, v72
    v_mfma_f32_16x16x32_bf16 v[28:31], v[172:175], a[80:83], 0
    v_fmac_f32 v47, v33, v73
    v_fmac_f32 v47, v34, v74
    v_mfma_f32_16x16x32_bf16 v[164:167], v[92:95], v[120:123], v[164:167]
    v_fmac_f32 v47, v35, v75
    v_fmac_f32 v47, v36, v68
    v_mfma_f32_16x16x32_bf16 v[32:35], a[80:83], a[80:83], 0
    buffer_load_dwordx4 v7, s[24:27], 0 offen  lds
    s_add_u32 m0, s54, 86688
    v_add_u32_dpp v7, v201, v6 quad_perm:[2,2,2,2] row_mask:0xf bank_mask:0xf
    v_mfma_f32_16x16x32_bf16 v[168:171], v[96:99], v[120:123], v[168:171]
    buffer_load_dwordx4 v7, s[24:27], 0 offen  lds
    v_fmac_f32 v47, v37, v69
    v_fmac_f32 v47, v38, v70
    v_fmac_f32 v47, v39, v71
    v_mfma_f32_16x16x32_bf16 v[36:39], a[16:19], a[80:83], 0
    v_fmac_f32 v48, v29, v60
    v_fmac_f32 v48, v32, v72
L_step33:
    v_fmac_f32 v48, v33, v73
    v_fmac_f32 v48, v34, v74
    v_fmac_f32 v48, v35, v75
    s_waitcnt vmcnt(8) lgkmcnt(0)
    v_mfma_f32_16x16x32_bf16 v[140:143], v[100:103], v[124:127], v[140:143]
    s_barrier
    ds_read_b64_tr_b16 v[92:93], v4 offset:32768
    ds_read_b128 v[108:111], v0 offset:41280
    s_add_u32 m0, s55, 16384
    s_mov_b32 s56, 270336
    v_mfma_f32_16x16x32_bf16 v[148:151], v[100:103], v[128:131], v[148:151]
    buffer_load_dwordx4 v5, s[28:31], s56 offen  lds
    ds_read_b64_tr_b16 v[94:95], v4 offset:33792
    v_mfma_f32_16x16x32_bf16 v[152:155], v[104:107], v[128:131], v[152:155]
    ds_read_b128 v[112:115], v0 offset:42304
    ds_read_b64_tr_b16 v[96:97], v2 offset:32768
    v_mfma_f32_16x16x32_bf16 v[144:147], v[104:107], v[124:127], v[144:147]
    ds_read_b128 v[116:119], v0 offset:43328
    v_fmac_f32 v48, v36, v68
    v_mfma_f32_16x16x32_bf16 v[28:31], v[176:179], a[84:87], 0
    ds_read_b64_tr_b16 v[98:99], v2 offset:33792
    v_fmac_f32 v48, v37, v69
    v_mfma_f32_16x16x32_bf16 v[160:163], v[104:107], v[132:135], v[160:163]
    buffer_load_dwordx4 v5, s[28:31], s56 offen offset:1024  lds
    s_add_u32 m0, s54, 90816
    v_add_u32_dpp v7, v202, v6 quad_perm:[2,2,2,2] row_mask:0xf bank_mask:0xf
    v_mfma_f32_16x16x32_bf16 v[156:159], v[100:103], v[132:135], v[156:159]
    ds_read_b128 v[120:123], v0 offset:44352
    v_fmac_f32 v48, v38, v70
    v_mfma_f32_16x16x32_bf16 v[32:35], a[84:87], a[84:87], 0
    v_fmac_f32 v48, v39, v71
    v_fmac_f32 v49, v29, v60
    v_mfma_f32_16x16x32_bf16 v[164:167], v[100:103], v[136:139], v[164:167]
    buffer_load_dwordx4 v7, s[24:27], 0 offen  lds
    v_mfma_f32_16x16x32_bf16 v[168:171], v[104:107], v[136:139], v[168:171]
    v_mfma_f32_16x16x32_bf16 v[36:39], a[20:23], a[84:87], 0
L_step34:
    s_waitcnt vmcnt(7) lgkmcnt(0)
    v_mfma_f32_16x16x32_bf16 v[140:143], v[92:95], v[108:111], v[140:143]
    s_barrier
    ds_read_b64_tr_b16 v[100:101], v4 offset:0
    ds_read_b128 v[124:127], v0 offset:45408
    s_add_u32 m0, s55, 24576
    s_mov_b32 s56, 278528
    v_mfma_f32_16x16x32_bf16 v[148:151], v[92:95], v[112:115], v[148:151]
    buffer_load_dwordx4 v5, s[28:31], s56 offen  lds
    ds_read_b64_tr_b16 v[102:103], v4 offset:1024
    v_mfma_f32_16x16x32_bf16 v[152:155], v[96:99], v[112:115], v[152:155]
    ds_read_b128 v[128:131], v0 offset:46432
    v_fmac_f32 v49, v32, v72
    v_mfma_f32_16x16x32_bf16 v[144:147], v[96:99], v[108:111], v[144:147]
    ds_read_b64_tr_b16 v[104:105], v2 offset:0
    v_fmac_f32 v49, v33, v73
    v_mfma_f32_16x16x32_bf16 v[28:31], v[180:183], a[88:91], 0
    ds_read_b32 v61, v13 offset:544
    ds_read_b128 v[132:135], v0 offset:47456
    v_mfma_f32_16x16x32_bf16 v[160:163], v[96:99], v[116:119], v[160:163]
    buffer_load_dwordx4 v5, s[28:31], s56 offen offset:1024  lds
    s_add_u32 m0, s54, 94944
    v_add_u32_dpp v7, v203, v6 quad_perm:[2,2,2,2] row_mask:0xf bank_mask:0xf
    v_mfma_f32_16x16x32_bf16 v[156:159], v[92:95], v[116:119], v[156:159]
    ds_read_b64_tr_b16 v[106:107], v2 offset:1024
    v_fmac_f32 v49, v34, v74
    v_fmac_f32 v49, v35, v75
    v_mfma_f32_16x16x32_bf16 v[32:35], a[88:91], a[88:91], 0
    ds_read_b128 v[136:139], v0 offset:48480
    v_fmac_f32 v49, v36, v68
    v_mfma_f32_16x16x32_bf16 v[164:167], v[92:95], v[120:123], v[164:167]
    v_fmac_f32 v49, v37, v69
    v_fmac_f32 v49, v38, v70
    v_fmac_f32 v49, v39, v71
    v_mfma_f32_16x16x32_bf16 v[36:39], a[24:27], a[88:91], 0
    buffer_load_dwordx4 v7, s[24:27], 0 offen  lds
    v_fmac_f32 v50, v29, v60
    v_mfma_f32_16x16x32_bf16 v[168:171], v[96:99], v[120:123], v[168:171]
    v_fmac_f32 v50, v32, v72
    v_fmac_f32 v50, v33, v73
    v_mfma_f32_16x16x32_bf16 v[28:31], v[184:187], a[92:95], 0
    v_fmac_f32 v50, v34, v74
    v_fmac_f32 v50, v35, v75
L_step35:
    s_waitcnt vmcnt(8) lgkmcnt(0)
    v_mfma_f32_16x16x32_bf16 v[140:143], v[100:103], v[124:127], v[140:143]
    s_barrier
    ds_read_b64_tr_b16 v[92:93], v4 offset:8192
    ds_read_b128 v[108:111], v1 offset:0
    s_add_u32 m0, s55, 32768
    s_mov_b32 s56, 286720
    v_mbcnt_lo_u32_b32 v19, -1, 0
    v_mbcnt_hi_u32_b32 v19, -1, v19
    s_lshl_b32 s57, s52, 6
    v_lshrrev_b32 v16, 1, v11
    s_add_u32 s59, s57, 163440
    v_add_u32 v16, s59, v16
    v_lshlrev_b32 v15, 1, v19
    v_mfma_f32_16x16x32_bf16 v[148:151], v[100:103], v[128:131], v[148:151]
    ds_read_b64 v[42:43], v16 offset:0
    ds_read_b64 v[64:65], v16 offset:32
    v_mfma_f32_16x16x32_bf16 v[152:155], v[104:107], v[128:131], v[152:155]
    buffer_load_dwordx4 v5, s[28:31], s56 offen  lds
    ds_read_b64_tr_b16 v[94:95], v4 offset:9216
    v_mfma_f32_16x16x32_bf16 v[144:147], v[104:107], v[124:127], v[144:147]
    ds_read_b128 v[112:115], v1 offset:1024
    ds_read_b64_tr_b16 v[96:97], v2 offset:8192
    v_mfma_f32_16x16x32_bf16 v[32:35], a[92:95], a[92:95], 0
    ds_read_b128 v[116:119], v1 offset:2048
    v_fmac_f32 v50, v36, v68
    v_mfma_f32_16x16x32_bf16 v[160:163], v[104:107], v[132:135], v[160:163]
    ds_read_b64_tr_b16 v[98:99], v2 offset:9216
    v_fmac_f32 v50, v37, v69
    v_mfma_f32_16x16x32_bf16 v[156:159], v[100:103], v[132:135], v[156:159]
    buffer_load_dwordx4 v5, s[28:31], s56 offen offset:1024  lds
    s_add_u32 m0, s54, 0
    v_add_u32_dpp v7, v200, v6 quad_perm:[3,3,3,3] row_mask:0xf bank_mask:0xf
    v_fmac_f32 v50, v38, v70
    v_fmac_f32 v50, v39, v71
    v_mfma_f32_16x16x32_bf16 v[36:39], a[28:31], a[92:95], 0
    ds_read_b128 v[120:123], v1 offset:3072
    v_fmac_f32 v51, v29, v60
    v_mfma_f32_16x16x32_bf16 v[164:167], v[100:103], v[136:139], v[164:167]
    v_fmac_f32 v51, v32, v72
    v_fmac_f32 v51, v33, v73
    v_mfma_f32_16x16x32_bf16 v[28:31], v[172:175], a[96:99], 0
    ds_read_b128 v[76:79], v12 offset:5120
    buffer_load_dwordx4 v7, s[24:27], 0 offen  lds
    v_mfma_f32_16x16x32_bf16 v[168:171], v[104:107], v[136:139], v[168:171]
    v_fmac_f32 v51, v34, v74
    v_fmac_f32 v51, v35, v75
    v_mfma_f32_16x16x32_bf16 v[32:35], a[96:99], a[96:99], 0
    v_fmac_f32 v51, v36, v68
    v_fmac_f32 v51, v37, v69
L_step36:
    s_waitcnt vmcnt(7) lgkmcnt(1)
    v_mfma_f32_16x16x32_bf16 v[140:143], v[92:95], v[108:111], v[140:143]
    s_barrier
    ds_read_b64_tr_b16 v[100:101], v4 offset:16384
    ds_read_b128 v[124:127], v1 offset:4128
    s_add_u32 m0, s55, 0
    s_mov_b32 s56, 294912
    v_mfma_f32_16x16x32_bf16 v[148:151], v[92:95], v[112:115], v[148:151]
    buffer_load_dwordx4 v5, s[28:31], s56 offen  lds
    ds_read_b64_tr_b16 v[102:103], v4 offset:17408
    v_mfma_f32_16x16x32_bf16 v[152:155], v[96:99], v[112:115], v[152:155]
    ds_read_b128 v[128:131], v1 offset:5152
    ds_read_b64_tr_b16 v[104:105], v2 offset:16384
    v_mfma_f32_16x16x32_bf16 v[144:147], v[96:99], v[108:111], v[144:147]
    ds_read_b128 v[132:135], v1 offset:6176
    v_fmac_f32 v51, v38, v70
    v_fmac_f32 v51, v39, v71
    v_mfma_f32_16x16x32_bf16 v[36:39], a[32:35], a[96:99], 0
    ds_read_b64_tr_b16 v[106:107], v2 offset:17408
    v_fmac_f32 v52, v30, v60
    v_mfma_f32_16x16x32_bf16 v[160:163], v[96:99], v[116:119], v[160:163]
    buffer_load_dwordx4 v5, s[28:31], s56 offen offset:1024  lds
    s_add_u32 m0, s54, 4128
    v_add_u32_dpp v7, v201, v6 quad_perm:[3,3,3,3] row_mask:0xf bank_mask:0xf
    v_mfma_f32_16x16x32_bf16 v[156:159], v[92:95], v[116:119], v[156:159]
    ds_read_b128 v[136:139], v1 offset:7200
    v_fmac_f32 v52, v32, v72
    v_mfma_f32_16x16x32_bf16 v[28:31], v[176:179], a[100:103], 0
    v_fmac_f32 v52, v33, v73
    v_fmac_f32 v52, v34, v74
    v_mfma_f32_16x16x32_bf16 v[164:167], v[92:95], v[120:123], v[164:167]
    v_fmac_f32 v52, v35, v75
    v_fmac_f32 v52, v36, v68
    v_mfma_f32_16x16x32_bf16 v[32:35], a[100:103], a[100:103], 0
    buffer_load_dwordx4 v7, s[24:27], 0 offen  lds
    s_add_u32 m0, s54, 8256
    v_add_u32_dpp v7, v202, v6 quad_perm:[3,3,3,3] row_mask:0xf bank_mask:0xf
    v_mfma_f32_16x16x32_bf16 v[168:171], v[96:99], v[120:123], v[168:171]
    buffer_load_dwordx4 v7, s[24:27], 0 offen  lds
    v_fmac_f32 v52, v37, v69
    v_fmac_f32 v52, v38, v70
    v_fmac_f32 v52, v39, v71
    v_mfma_f32_16x16x32_bf16 v[36:39], a[36:39], a[100:103], 0
    v_fmac_f32 v53, v30, v60
    v_fmac_f32 v53, v32, v72
L_step37:
    v_fmac_f32 v53, v33, v73
    v_fmac_f32 v53, v34, v74
    v_fmac_f32 v53, v35, v75
    s_waitcnt vmcnt(8) lgkmcnt(0)
    v_mfma_f32_16x16x32_bf16 v[140:143], v[100:103], v[124:127], v[140:143]
    s_barrier
    ds_read_b64_tr_b16 v[92:93], v4 offset:24576
    ds_read_b128 v[108:111], v1 offset:8256
    s_add_u32 m0, s55, 8192
    s_mov_b32 s56, 303104
    v_mfma_f32_16x16x32_bf16 v[148:151], v[100:103], v[128:131], v[148:151]
    buffer_load_dwordx4 v5, s[28:31], s56 offen  lds
    ds_read_b64_tr_b16 v[94:95], v4 offset:25600
    v_mfma_f32_16x16x32_bf16 v[152:155], v[104:107], v[128:131], v[152:155]
    ds_read_b128 v[112:115], v1 offset:9280
    ds_read_b64_tr_b16 v[96:97], v2 offset:24576
    v_mfma_f32_16x16x32_bf16 v[144:147], v[104:107], v[124:127], v[144:147]
    ds_read_b128 v[116:119], v1 offset:10304
    v_fmac_f32 v53, v36, v68
    v_mfma_f32_16x16x32_bf16 v[28:31], v[180:183], a[104:107], 0
    ds_read_b64_tr_b16 v[98:99], v2 offset:25600
    v_fmac_f32 v53, v37, v69
    v_mfma_f32_16x16x32_bf16 v[160:163], v[104:107], v[132:135], v[160:163]
    buffer_load_dwordx4 v5, s[28:31], s56 offen offset:1024  lds
    s_add_u32 m0, s54, 12384
    v_add_u32_dpp v7, v203, v6 quad_perm:[3,3,3,3] row_mask:0xf bank_mask:0xf
    v_mfma_f32_16x16x32_bf16 v[156:159], v[100:103], v[132:135], v[156:159]
    ds_read_b128 v[120:123], v1 offset:11328
    v_fmac_f32 v53, v38, v70
    v_mfma_f32_16x16x32_bf16 v[32:35], a[104:107], a[104:107], 0
    v_fmac_f32 v53, v39, v71
    v_fmac_f32 v54, v30, v60
    v_mfma_f32_16x16x32_bf16 v[164:167], v[100:103], v[136:139], v[164:167]
    buffer_load_dwordx4 v7, s[24:27], 0 offen  lds
    v_lshlrev_b32 v40, 16, v42
    v_mfma_f32_16x16x32_bf16 v[168:171], v[104:107], v[136:139], v[168:171]
    v_and_b32 v41, 0xffff0000, v42
    v_lshlrev_b32 v42, 16, v43
    v_mfma_f32_16x16x32_bf16 v[36:39], a[40:43], a[104:107], 0
    v_fmac_f32 v54, v32, v72
    v_fmac_f32 v54, v33, v73
L_step38:
    s_waitcnt vmcnt(8) lgkmcnt(0)
    v_mfma_f32_16x16x32_bf16 v[140:143], v[92:95], v[108:111], v[140:143]
    s_barrier
    ds_read_b64_tr_b16 v[100:101], v4 offset:32768
    ds_read_b128 v[124:127], v1 offset:12384
    s_add_u32 m0, s55, 16384
    s_mov_b32 s56, 311296
    v_mfma_f32_16x16x32_bf16 v[148:151], v[92:95], v[112:115], v[148:151]
    buffer_load_dwordx4 v5, s[28:31], s56 offen  lds
    ds_read_b64_tr_b16 v[102:103], v4 offset:33792
    v_mfma_f32_16x16x32_bf16 v[152:155], v[96:99], v[112:115], v[152:155]
    ds_read_b128 v[128:131], v1 offset:13408
    v_fmac_f32 v54, v34, v74
    v_mfma_f32_16x16x32_bf16 v[144:147], v[96:99], v[108:111], v[144:147]
    ds_read_b64_tr_b16 v[104:105], v2 offset:32768
    v_fmac_f32 v54, v35, v75
    v_mfma_f32_16x16x32_bf16 v[28:31], v[184:187], a[108:111], 0
    ds_read_b128 v[132:135], v1 offset:14432
    v_fmac_f32 v54, v36, v68
    v_mfma_f32_16x16x32_bf16 v[160:163], v[96:99], v[116:119], v[160:163]
    buffer_load_dwordx4 v5, s[28:31], s56 offen offset:1024  lds
    s_add_u32 m0, s54, 16512
    v_add_u32_dpp v7, v204, v6 quad_perm:[0,0,0,0] row_mask:0xf bank_mask:0xf
    v_mfma_f32_16x16x32_bf16 v[156:159], v[92:95], v[116:119], v[156:159]
    ds_read_b64_tr_b16 v[106:107], v2 offset:33792
    v_fmac_f32 v54, v37, v69
    v_mfma_f32_16x16x32_bf16 v[32:35], a[108:111], a[108:111], 0
    ds_read_b128 v[136:139], v1 offset:15456
    v_fmac_f32 v54, v38, v70
    v_mfma_f32_16x16x32_bf16 v[164:167], v[92:95], v[120:123], v[164:167]
    v_fmac_f32 v54, v39, v71
    v_fmac_f32 v55, v30, v60
    v_mfma_f32_16x16x32_bf16 v[36:39], a[44:47], a[108:111], 0
    buffer_load_dwordx4 v7, s[24:27], 0 offen  lds
    v_and_b32 v43, 0xffff0000, v43
    v_mfma_f32_16x16x32_bf16 v[168:171], v[96:99], v[120:123], v[168:171]
    v_fmac_f32 v55, v32, v72
    v_fmac_f32 v55, v33, v73
    v_mfma_f32_16x16x32_bf16 v[28:31], v[172:175], a[112:115], 0
    v_fmac_f32 v55, v34, v74
    v_fmac_f32 v55, v35, v75
L_step39:
    s_waitcnt vmcnt(8) lgkmcnt(0)
    v_mfma_f32_16x16x32_bf16 v[140:143], v[100:103], v[124:127], v[140:143]
    s_barrier
    ds_read_b64_tr_b16 v[92:93], v4 offset:0
    ds_read_b128 v[108:111], v1 offset:16512
    s_add_u32 m0, s55, 24576
    s_mov_b32 s56, 319488
    v_mfma_f32_16x16x32_bf16 v[148:151], v[100:103], v[128:131], v[148:151]
    buffer_load_dwordx4 v5, s[28:31], s56 offen  lds
    ds_read_b64_tr_b16 v[94:95], v4 offset:1024
    v_mfma_f32_16x16x32_bf16 v[152:155], v[104:107], v[128:131], v[152:155]
    ds_read_b128 v[112:115], v1 offset:17536
    v_fmac_f32 v55, v36, v68
    v_mfma_f32_16x16x32_bf16 v[144:147], v[104:107], v[124:127], v[144:147]
    ds_read_b64_tr_b16 v[96:97], v2 offset:0
    v_fmac_f32 v55, v37, v69
    v_mfma_f32_16x16x32_bf16 v[32:35], a[112:115], a[112:115], 0
    ds_read_b128 v[116:119], v1 offset:18560
    v_fmac_f32 v55, v38, v70
    v_mfma_f32_16x16x32_bf16 v[160:163], v[104:107], v[132:135], v[160:163]
    buffer_load_dwordx4 v5, s[28:31], s56 offen offset:1024  lds
    s_add_u32 m0, s54, 20640
    v_add_u32_dpp v7, v205, v6 quad_perm:[0,0,0,0] row_mask:0xf bank_mask:0xf
    v_mfma_f32_16x16x32_bf16 v[156:159], v[100:103], v[132:135], v[156:159]
    ds_read_b64_tr_b16 v[98:99], v2 offset:1024
    v_fmac_f32 v55, v39, v71
    v_mfma_f32_16x16x32_bf16 v[36:39], a[48:51], a[112:115], 0
    ds_read_b128 v[120:123], v1 offset:19584
    v_fmac_f32 v56, v31, v60
    v_mfma_f32_16x16x32_bf16 v[164:167], v[100:103], v[136:139], v[164:167]
    v_fmac_f32 v56, v32, v72
    v_fmac_f32 v56, v33, v73
    v_mfma_f32_16x16x32_bf16 v[28:31], v[176:179], a[116:119], 0
    buffer_load_dwordx4 v7, s[24:27], 0 offen  lds
    v_fmac_f32 v56, v34, v74
    v_mfma_f32_16x16x32_bf16 v[168:171], v[104:107], v[136:139], v[168:171]
    v_fmac_f32 v56, v35, v75
    v_fmac_f32 v56, v36, v68
    v_mfma_f32_16x16x32_bf16 v[32:35], a[116:119], a[116:119], 0
    v_fmac_f32 v56, v37, v69
    v_fmac_f32 v56, v38, v70
L_step40:
    v_fmac_f32 v56, v39, v71
    v_fmac_f32 v57, v31, v60
    s_waitcnt vmcnt(7) lgkmcnt(0)
    v_mfma_f32_16x16x32_bf16 v[140:143], v[92:95], v[108:111], v[140:143]
    s_barrier
    ds_read_b64_tr_b16 v[100:101], v4 offset:8192
    ds_read_b128 v[124:127], v1 offset:20640
    s_add_u32 m0, s55, 32768
    s_mov_b32 s56, 327680
    v_mfma_f32_16x16x32_bf16 v[148:151], v[92:95], v[112:115], v[148:151]
    buffer_load_dwordx4 v5, s[28:31], s56 offen  lds
    ds_read_b64_tr_b16 v[102:103], v4 offset:9216
    v_mfma_f32_16x16x32_bf16 v[152:155], v[96:99], v[112:115], v[152:155]
    ds_read_b128 v[128:131], v1 offset:21664
    ds_read_b64_tr_b16 v[104:105], v2 offset:8192
    v_mfma_f32_16x16x32_bf16 v[144:147], v[96:99], v[108:111], v[144:147]
    ds_read_b128 v[132:135], v1 offset:22688
    ds_read_b64_tr_b16 v[106:107], v2 offset:9216
    v_mfma_f32_16x16x32_bf16 v[36:39], a[52:55], a[116:119], 0
    ds_read_b128 v[136:139], v1 offset:23712
    v_fmac_f32 v57, v32, v72
    v_mfma_f32_16x16x32_bf16 v[160:163], v[96:99], v[116:119], v[160:163]
    buffer_load_dwordx4 v5, s[28:31], s56 offen offset:1024  lds
    s_add_u32 m0, s54, 24768
    v_add_u32_dpp v7, v206, v6 quad_perm:[0,0,0,0] row_mask:0xf bank_mask:0xf
    v_mfma_f32_16x16x32_bf16 v[156:159], v[92:95], v[116:119], v[156:159]
    v_fmac_f32 v57, v33, v73
    v_fmac_f32 v57, v34, v74
    v_mfma_f32_16x16x32_bf16 v[28:31], v[180:183], a[120:123], 0
    v_fmac_f32 v57, v35, v75
    v_fmac_f32 v57, v36, v68
    v_mfma_f32_16x16x32_bf16 v[164:167], v[92:95], v[120:123], v[164:167]
    buffer_load_dwordx4 v7, s[24:27], 0 offen  lds
    s_add_u32 m0, s54, 28896
    v_add_u32_dpp v7, v207, v6 quad_perm:[0,0,0,0] row_mask:0xf bank_mask:0xf
    v_mfma_f32_16x16x32_bf16 v[168:171], v[96:99], v[120:123], v[168:171]
    buffer_load_dwordx4 v7, s[24:27], 0 offen  lds
    v_add_u32 v190, L_step48-L_pc, v189
    v_mfma_f32_16x16x32_bf16 v[32:35], a[120:123], a[120:123], 0
    global_load_dword v190, v190, s[62:63]
    v_fmac_f32 v57, v37, v69
L_step41:
    s_waitcnt vmcnt(9) lgkmcnt(0)
    v_mfma_f32_16x16x32_bf16 v[140:143], v[100:103], v[124:127], v[140:143]
    s_barrier
    ds_read_b64_tr_b16 v[92:93], v4 offset:16384
    ds_read_b128 v[108:111], v1 offset:24768
    s_add_u32 m0, s55, 0
    s_mov_b32 s56, 335872
    s_mov_b32 vcc_lo, 0xf000f000
    s_mov_b32 vcc_hi, 0xf000f000
    v_add_u32 v9, 49536, v8
    v_subrev_u32 v17, 49536, v8
    v_cndmask_b32 v9, v9, v17, vcc
    v_xad_u32 v10, v11, 0, v9
    v_mfma_f32_16x16x32_bf16 v[148:151], v[100:103], v[128:131], v[148:151]
    ds_read_b128 a[128:131], v10 offset:0
    ds_read_b128 a[132:135], v10 offset:64
    v_mfma_f32_16x16x32_bf16 v[152:155], v[104:107], v[128:131], v[152:155]
    ds_read_b128 a[136:139], v10 offset:128
    buffer_load_dwordx4 v5, s[28:31], s56 offen  lds
    v_mfma_f32_16x16x32_bf16 v[144:147], v[104:107], v[124:127], v[144:147]
    ds_read_b128 a[140:143], v10 offset:192
    ds_read_b64_tr_b16 v[94:95], v4 offset:17408
    v_fmac_f32 v57, v38, v70
    v_fmac_f32 v57, v39, v71
    v_mfma_f32_16x16x32_bf16 v[36:39], a[56:59], a[120:123], 0
    ds_read_b128 v[112:115], v1 offset:25792
    ds_read_b64_tr_b16 v[96:97], v2 offset:16384
    v_mfma_f32_16x16x32_bf16 v[160:163], v[104:107], v[132:135], v[160:163]
    ds_read_b128 v[116:119], v1 offset:26816
    v_fmac_f32 v58, v31, v60
    v_mfma_f32_16x16x32_bf16 v[156:159], v[100:103], v[132:135], v[156:159]
    buffer_load_dwordx4 v5, s[28:31], s56 offen offset:1024  lds
    ds_read_b64_tr_b16 v[98:99], v2 offset:17408
    s_add_u32 m0, s54, 33024
    v_add_u32_dpp v7, v204, v6 quad_perm:[1,1,1,1] row_mask:0xf bank_mask:0xf
    v_mfma_f32_16x16x32_bf16 v[28:31], v[184:187], a[124:127], 0
    ds_read_b128 v[120:123], v1 offset:27840
    v_fmac_f32 v58, v32, v72
    v_mfma_f32_16x16x32_bf16 v[164:167], v[100:103], v[136:139], v[164:167]
    v_fmac_f32 v58, v33, v73
    v_fmac_f32 v58, v34, v74
    v_fmac_f32 v58, v35, v75
    v_mfma_f32_16x16x32_bf16 v[32:35], a[124:127], a[124:127], 0
    buffer_load_dwordx4 v7, s[24:27], 0 offen  lds
    v_fmac_f32 v58, v36, v68
    v_mfma_f32_16x16x32_bf16 v[168:171], v[104:107], v[136:139], v[168:171]
    v_fmac_f32 v58, v37, v69
    v_fmac_f32 v58, v38, v70
    v_fmac_f32 v58, v39, v71
    v_mfma_f32_16x16x32_bf16 v[36:39], a[60:63], a[124:127], 0
    v_fmac_f32 v59, v31, v60
    v_fmac_f32 v59, v32, v72
L_step42:
    s_waitcnt vmcnt(9) lgkmcnt(0)
    v_mfma_f32_16x16x32_bf16 v[140:143], v[92:95], v[108:111], v[140:143]
    s_barrier
    ds_read_b64_tr_b16 v[100:101], v4 offset:24576
    ds_read_b128 v[124:127], v1 offset:28896
    s_add_u32 m0, s55, 8192
    s_mov_b32 s56, 344064
    v_xad_u32 v10, v11, 48, v9
    v_mfma_f32_16x16x32_bf16 v[148:151], v[92:95], v[112:115], v[148:151]
    ds_read_b128 a[144:147], v10 offset:256
    ds_read_b128 a[148:151], v10 offset:320
    v_mfma_f32_16x16x32_bf16 v[152:155], v[96:99], v[112:115], v[152:155]
    ds_read_b128 a[152:155], v10 offset:384
    buffer_load_dwordx4 v5, s[28:31], s56 offen  lds
    v_mfma_f32_16x16x32_bf16 v[144:147], v[96:99], v[108:111], v[144:147]
    ds_read_b128 a[156:159], v10 offset:448
    ds_read_b64_tr_b16 v[102:103], v4 offset:25600
    v_mfma_f32_16x16x32_bf16 v[28:31], v[172:175], a[128:131], 0
    ds_read_b128 v[128:131], v1 offset:29920
    v_fmac_f32 v59, v33, v73
    v_mfma_f32_16x16x32_bf16 v[160:163], v[96:99], v[116:119], v[160:163]
    ds_read_b64_tr_b16 v[104:105], v2 offset:24576
    ds_read_b128 v[132:135], v1 offset:30944
    v_fmac_f32 v59, v34, v74
    v_fmac_f32 v59, v35, v75
    v_mfma_f32_16x16x32_bf16 v[32:35], a[128:131], a[128:131], 0
    ds_read_b128 v[72:75], v12 offset:4096
    buffer_load_dwordx4 v5, s[28:31], s56 offen offset:1024  lds
    s_add_u32 m0, s54, 37152
    v_add_u32_dpp v7, v205, v6 quad_perm:[1,1,1,1] row_mask:0xf bank_mask:0xf
    v_mfma_f32_16x16x32_bf16 v[156:159], v[92:95], v[116:119], v[156:159]
    ds_read_b64_tr_b16 v[106:107], v2 offset:25600
    v_fmac_f32 v59, v36, v68
    v_fmac_f32 v59, v37, v69
    v_fmac_f32 v59, v38, v70
    v_fmac_f32 v59, v39, v71
    v_mfma_f32_16x16x32_bf16 v[36:39], a[0:3], a[128:131], 0
    ds_read_b128 v[68:71], v12 offset:3072
    ds_read_b128 v[136:139], v1 offset:31968
    v_mfma_f32_16x16x32_bf16 v[164:167], v[92:95], v[120:123], v[164:167]
    buffer_load_dwordx4 v7, s[24:27], 0 offen  lds
    v_fmac_f32 v44, v28, v61
    v_mfma_f32_16x16x32_bf16 v[28:31], a[64:67], a[128:131], 0
    v_fmac_f32 v44, v32, v76
    v_fmac_f32 v44, v33, v77
    v_mfma_f32_16x16x32_bf16 v[168:171], v[96:99], v[120:123], v[168:171]
    v_fmac_f32 v44, v34, v78
    v_fmac_f32 v44, v35, v79
    v_mfma_f32_16x16x32_bf16 v[32:35], v[176:179], a[132:135], 0
    s_waitcnt lgkmcnt(1)
    v_fmac_f32 v44, v36, v68
L_step43:
    s_waitcnt vmcnt(9) lgkmcnt(0)
    v_mfma_f32_16x16x32_bf16 v[140:143], v[100:103], v[124:127], v[140:143]
    s_barrier
    ds_read_b64_tr_b16 v[92:93], v4 offset:32768
    ds_read_b128 v[108:111], v1 offset:33024
    s_add_u32 m0, s55, 16384
    s_mov_b32 s56, 352256
    v_xad_u32 v10, v11, 32, v9
    v_mfma_f32_16x16x32_bf16 v[148:151], v[100:103], v[128:131], v[148:151]
    ds_read_b128 a[160:163], v10 offset:512
    ds_read_b128 a[164:167], v10 offset:576
    v_mfma_f32_16x16x32_bf16 v[152:155], v[104:107], v[128:131], v[152:155]
    ds_read_b128 a[168:171], v10 offset:640
    buffer_load_dwordx4 v5, s[28:31], s56 offen  lds
    v_mfma_f32_16x16x32_bf16 v[144:147], v[104:107], v[124:127], v[144:147]
    ds_read_b128 a[172:175], v10 offset:704
    ds_read_b64_tr_b16 v[94:95], v4 offset:33792
    v_fmac_f32 v44, v37, v69
    v_fmac_f32 v44, v38, v70
    v_fmac_f32 v44, v39, v71
    v_mfma_f32_16x16x32_bf16 v[36:39], a[132:135], a[132:135], 0
    ds_read_b128 v[112:115], v1 offset:34048
    ds_read_b64_tr_b16 v[96:97], v2 offset:32768
    v_mfma_f32_16x16x32_bf16 v[160:163], v[104:107], v[132:135], v[160:163]
    ds_read_b128 v[116:119], v1 offset:35072
    buffer_load_dwordx4 v5, s[28:31], s56 offen offset:1024  lds
    s_add_u32 m0, s54, 41280
    v_add_u32_dpp v7, v206, v6 quad_perm:[1,1,1,1] row_mask:0xf bank_mask:0xf
    v_mfma_f32_16x16x32_bf16 v[156:159], v[100:103], v[132:135], v[156:159]
    ds_read_b64_tr_b16 v[98:99], v2 offset:33792
    v_fmac_f32 v44, v28, v72
    v_fmac_f32 v44, v29, v73
    v_fmac_f32 v44, v30, v74
    v_fmac_f32 v44, v31, v75
    v_mfma_f32_16x16x32_bf16 v[28:31], a[4:7], a[132:135], 0
    ds_read_b128 v[120:123], v1 offset:36096
    v_fmac_f32 v45, v32, v61
    v_mfma_f32_16x16x32_bf16 v[164:167], v[100:103], v[136:139], v[164:167]
    buffer_load_dwordx4 v7, s[24:27], 0 offen  lds
    v_fmac_f32 v45, v36, v76
    v_mfma_f32_16x16x32_bf16 v[32:35], a[68:71], a[132:135], 0
    v_fmac_f32 v45, v37, v77
    v_fmac_f32 v45, v38, v78
    v_mfma_f32_16x16x32_bf16 v[168:171], v[104:107], v[136:139], v[168:171]
    v_fmac_f32 v45, v39, v79
    v_fmac_f32 v45, v28, v68
    v_mfma_f32_16x16x32_bf16 v[36:39], v[180:183], a[136:139], 0
    v_fmac_f32 v45, v29, v69
    v_fmac_f32 v45, v30, v70
L_step44:
    s_waitcnt vmcnt(7) lgkmcnt(0)
    v_mfma_f32_16x16x32_bf16 v[140:143], v[92:95], v[108:111], v[140:143]
    s_barrier
    ds_read_b64_tr_b16 v[100:101], v4 offset:0
    ds_read_b128 v[124:127], v1 offset:37152
    s_add_u32 m0, s55, 24576
    s_mov_b32 s56, 360448
    v_xad_u32 v10, v11, 16, v9
    v_mfma_f32_16x16x32_bf16 v[148:151], v[92:95], v[112:115], v[148:151]
    ds_read_b128 a[176:179], v10 offset:768
    ds_read_b128 a[180:183], v10 offset:832
    v_mfma_f32_16x16x32_bf16 v[152:155], v[96:99], v[112:115], v[152:155]
    ds_read_b128 a[184:187], v10 offset:896
    buffer_load_dwordx4 v5, s[28:31], s56 offen  lds
    v_mfma_f32_16x16x32_bf16 v[144:147], v[96:99], v[108:111], v[144:147]
    ds_read_b128 a[188:191], v10 offset:960
    ds_read_b64_tr_b16 v[102:103], v4 offset:1024
    v_fmac_f32 v45, v31, v71
    v_mfma_f32_16x16x32_bf16 v[28:31], a[136:139], a[136:139], 0
    ds_read_b128 v[128:131], v1 offset:38176
    v_fmac_f32 v45, v32, v72
    v_mfma_f32_16x16x32_bf16 v[160:163], v[96:99], v[116:119], v[160:163]
    ds_read_b64_tr_b16 v[104:105], v2 offset:0
    ds_read_b128 v[132:135], v1 offset:39200
    v_fmac_f32 v45, v33, v73
    v_fmac_f32 v45, v34, v74
    v_fmac_f32 v45, v35, v75
    v_mfma_f32_16x16x32_bf16 v[32:35], a[8:11], a[136:139], 0
    buffer_load_dwordx4 v5, s[28:31], s56 offen offset:1024  lds
    s_add_u32 m0, s54, 45408
    v_add_u32_dpp v7, v207, v6 quad_perm:[1,1,1,1] row_mask:0xf bank_mask:0xf
    v_mfma_f32_16x16x32_bf16 v[156:159], v[92:95], v[116:119], v[156:159]
    ds_read_b64_tr_b16 v[106:107], v2 offset:1024
    v_fmac_f32 v46, v36, v61
    v_mfma_f32_16x16x32_bf16 v[36:39], a[72:75], a[136:139], 0
    ds_read_b128 v[136:139], v1 offset:40224
    v_fmac_f32 v46, v28, v76
    v_mfma_f32_16x16x32_bf16 v[164:167], v[92:95], v[120:123], v[164:167]
    v_fmac_f32 v46, v29, v77
    v_fmac_f32 v46, v30, v78
    v_fmac_f32 v46, v31, v79
    v_mfma_f32_16x16x32_bf16 v[28:31], v[184:187], a[140:143], 0
    buffer_load_dwordx4 v7, s[24:27], 0 offen  lds
    v_fmac_f32 v46, v32, v68
    v_mfma_f32_16x16x32_bf16 v[168:171], v[96:99], v[120:123], v[168:171]
    v_fmac_f32 v46, v33, v69
    v_fmac_f32 v46, v34, v70
    v_fmac_f32 v46, v35, v71
    v_mfma_f32_16x16x32_bf16 v[32:35], a[140:143], a[140:143], 0
    v_fmac_f32 v46, v36, v72
    v_fmac_f32 v46, v37, v73
L_step45:
    s_waitcnt vmcnt(7) lgkmcnt(0)
    v_mfma_f32_16x16x32_bf16 v[140:143], v[100:103], v[124:127], v[140:143]
    s_barrier
    ds_read_b64_tr_b16 v[92:93], v4 offset:8192
    ds_read_b128 v[108:111], v1 offset:41280
    s_add_u32 m0, s55, 32768
    s_mov_b32 s56, 368640
    v_mfma_f32_16x16x32_bf16 v[148:151], v[100:103], v[128:131], v[148:151]
    buffer_load_dwordx4 v5, s[28:31], s56 offen  lds
    ds_read_b64_tr_b16 v[94:95], v4 offset:9216
    v_mfma_f32_16x16x32_bf16 v[152:155], v[104:107], v[128:131], v[152:155]
    ds_read_b128 v[112:115], v1 offset:42304
    v_fmac_f32 v46, v38, v74
    v_mfma_f32_16x16x32_bf16 v[144:147], v[104:107], v[124:127], v[144:147]
    ds_read_b64_tr_b16 v[96:97], v2 offset:8192
    v_fmac_f32 v46, v39, v75
    v_mfma_f32_16x16x32_bf16 v[36:39], a[12:15], a[140:143], 0
    ds_read_b128 v[116:119], v1 offset:43328
    v_fmac_f32 v47, v28, v61
    v_mfma_f32_16x16x32_bf16 v[160:163], v[104:107], v[132:135], v[160:163]
    buffer_load_dwordx4 v5, s[28:31], s56 offen offset:1024  lds
    s_add_u32 m0, s54, 49536
    v_add_u32_dpp v7, v204, v6 quad_perm:[2,2,2,2] row_mask:0xf bank_mask:0xf
    v_mfma_f32_16x16x32_bf16 v[156:159], v[100:103], v[132:135], v[156:159]
    ds_read_b64_tr_b16 v[98:99], v2 offset:9216
    v_fmac_f32 v47, v32, v76
    v_mfma_f32_16x16x32_bf16 v[28:31], a[76:79], a[140:143], 0
    ds_read_b128 v[120:123], v1 offset:44352
    v_fmac_f32 v47, v33, v77
    v_mfma_f32_16x16x32_bf16 v[164:167], v[100:103], v[136:139], v[164:167]
    v_fmac_f32 v47, v34, v78
    v_fmac_f32 v47, v35, v79
    v_mfma_f32_16x16x32_bf16 v[32:35], v[172:175], a[144:147], 0
    buffer_load_dwordx4 v7, s[24:27], 0 offen  lds
    v_fmac_f32 v47, v36, v68
    v_mfma_f32_16x16x32_bf16 v[168:171], v[104:107], v[136:139], v[168:171]
    v_fmac_f32 v47, v37, v69
    v_fmac_f32 v47, v38, v70
    v_fmac_f32 v47, v39, v71
    v_mfma_f32_16x16x32_bf16 v[36:39], a[144:147], a[144:147], 0
    v_fmac_f32 v47, v28, v72
    v_fmac_f32 v47, v29, v73
L_step46:
    s_waitcnt vmcnt(7) lgkmcnt(0)
    v_mfma_f32_16x16x32_bf16 v[140:143], v[92:95], v[108:111], v[140:143]
    s_barrier
    ds_read_b64_tr_b16 v[100:101], v4 offset:16384
    ds_read_b128 v[124:127], v1 offset:45408
    s_add_u32 m0, s55, 0
    s_mov_b32 s56, 376832
    v_mfma_f32_16x16x32_bf16 v[148:151], v[92:95], v[112:115], v[148:151]
    buffer_load_dwordx4 v5, s[28:31], s56 offen  lds
    v_fmac_f32 v47, v30, v74
    v_mfma_f32_16x16x32_bf16 v[152:155], v[96:99], v[112:115], v[152:155]
    ds_read_b64_tr_b16 v[102:103], v4 offset:17408
    v_fmac_f32 v47, v31, v75
    v_mfma_f32_16x16x32_bf16 v[144:147], v[96:99], v[108:111], v[144:147]
    ds_read_b128 v[128:131], v1 offset:46432
    v_fmac_f32 v48, v33, v61
    v_mfma_f32_16x16x32_bf16 v[28:31], a[16:19], a[144:147], 0
    ds_read_b64_tr_b16 v[104:105], v2 offset:16384
    v_fmac_f32 v48, v36, v76
    v_mfma_f32_16x16x32_bf16 v[160:163], v[96:99], v[116:119], v[160:163]
    buffer_load_dwordx4 v5, s[28:31], s56 offen offset:1024  lds
    s_add_u32 m0, s54, 53664
    v_add_u32_dpp v7, v205, v6 quad_perm:[2,2,2,2] row_mask:0xf bank_mask:0xf
    v_mfma_f32_16x16x32_bf16 v[32:35], a[80:83], a[144:147], 0
    ds_read_b128 v[132:135], v1 offset:47456
    v_fmac_f32 v48, v37, v77
    v_mfma_f32_16x16x32_bf16 v[156:159], v[92:95], v[116:119], v[156:159]
    ds_read_b64_tr_b16 v[106:107], v2 offset:17408
    v_fmac_f32 v48, v38, v78
    v_fmac_f32 v48, v39, v79
    v_mfma_f32_16x16x32_bf16 v[36:39], v[176:179], a[148:151], 0
    ds_read_b128 v[136:139], v1 offset:48480
    v_fmac_f32 v48, v28, v68
    v_mfma_f32_16x16x32_bf16 v[164:167], v[92:95], v[120:123], v[164:167]
    buffer_load_dwordx4 v7, s[24:27], 0 offen  lds
    v_fmac_f32 v48, v29, v69
    v_fmac_f32 v48, v30, v70
    v_fmac_f32 v48, v31, v71
    v_mfma_f32_16x16x32_bf16 v[28:31], a[148:151], a[148:151], 0
    v_fmac_f32 v48, v32, v72
    v_fmac_f32 v48, v33, v73
    v_mfma_f32_16x16x32_bf16 v[168:171], v[96:99], v[120:123], v[168:171]
    v_fmac_f32 v48, v34, v74
    v_fmac_f32 v48, v35, v75
    v_mfma_f32_16x16x32_bf16 v[32:35], a[20:23], a[148:151], 0
    v_fmac_f32 v49, v37, v61
    v_lshlrev_b32 v62, 16, v64
L_step47:
    s_waitcnt vmcnt(7) lgkmcnt(0)
    v_mfma_f32_16x16x32_bf16 v[140:143], v[100:103], v[124:127], v[140:143]
    s_barrier
    ds_read_b64_tr_b16 v[92:93], v4 offset:24576
    ds_read_b128 v[108:111], v0 offset:0
    s_add_u32 m0, s55, 8192
    s_mov_b32 s56, 385024
    v_mfma_f32_16x16x32_bf16 v[148:151], v[100:103], v[128:131], v[148:151]
    buffer_load_dwordx4 v5, s[28:31], s56 offen  lds
    ds_read_b64_tr_b16 v[94:95], v4 offset:25600
    v_mfma_f32_16x16x32_bf16 v[152:155], v[104:107], v[128:131], v[152:155]
    ds_read_b128 v[112:115], v0 offset:1024
    v_fmac_f32 v49, v28, v76
    v_mfma_f32_16x16x32_bf16 v[144:147], v[104:107], v[124:127], v[144:147]
    ds_read_b64_tr_b16 v[96:97], v2 offset:24576
    v_fmac_f32 v49, v29, v77
    v_mfma_f32_16x16x32_bf16 v[36:39], a[84:87], a[148:151], 0
    ds_read_b128 v[116:119], v0 offset:2048
    v_fmac_f32 v49, v30, v78
    v_mfma_f32_16x16x32_bf16 v[160:163], v[104:107], v[132:135], v[160:163]
    buffer_load_dwordx4 v5, s[28:31], s56 offen offset:1024  lds
    s_add_u32 m0, s54, 57792
    v_add_u32_dpp v7, v206, v6 quad_perm:[2,2,2,2] row_mask:0xf bank_mask:0xf
    v_mfma_f32_16x16x32_bf16 v[156:159], v[100:103], v[132:135], v[156:159]
    ds_read_b64_tr_b16 v[98:99], v2 offset:25600
    v_fmac_f32 v49, v31, v79
    v_mfma_f32_16x16x32_bf16 v[28:31], v[180:183], a[152:155], 0
    ds_read_b32 v60, v13 offset:816
    ds_read_b128 v[120:123], v0 offset:3072
    v_mfma_f32_16x16x32_bf16 v[164:167], v[100:103], v[136:139], v[164:167]
    v_fmac_f32 v49, v32, v68
    v_fmac_f32 v49, v33, v69
    v_fmac_f32 v49, v34, v70
    v_fmac_f32 v49, v35, v71
    v_mfma_f32_16x16x32_bf16 v[32:35], a[152:155], a[152:155], 0
    buffer_load_dwordx4 v7, s[24:27], 0 offen  lds
    v_fmac_f32 v49, v36, v72
    v_mfma_f32_16x16x32_bf16 v[168:171], v[104:107], v[136:139], v[168:171]
    v_fmac_f32 v49, v37, v73
    v_fmac_f32 v49, v38, v74
    v_fmac_f32 v49, v39, v75
    v_mfma_f32_16x16x32_bf16 v[36:39], a[24:27], a[152:155], 0
    v_fmac_f32 v50, v29, v61
    v_fmac_f32 v50, v32, v76
L_step48:
    s_waitcnt vmcnt(7) lgkmcnt(0)
    v_mfma_f32_16x16x32_bf16 v[140:143], v[92:95], v[108:111], v[140:143]
    s_barrier
    ds_read_b64_tr_b16 v[100:101], v4 offset:32768
    ds_read_b128 v[124:127], v0 offset:4128
    s_add_u32 m0, s55, 16384
    s_mov_b32 s56, 393216
    v_mfma_f32_16x16x32_bf16 v[148:151], v[92:95], v[112:115], v[148:151]
    buffer_load_dwordx4 v5, s[28:31], s56 offen  lds
    ds_read_b64_tr_b16 v[102:103], v4 offset:33792
    v_mfma_f32_16x16x32_bf16 v[152:155], v[96:99], v[112:115], v[152:155]
    ds_read_b128 v[128:131], v0 offset:5152
    v_fmac_f32 v50, v33, v77
    v_mfma_f32_16x16x32_bf16 v[144:147], v[96:99], v[108:111], v[144:147]
    ds_read_b64_tr_b16 v[104:105], v2 offset:32768
    v_fmac_f32 v50, v34, v78
    v_mfma_f32_16x16x32_bf16 v[28:31], a[88:91], a[152:155], 0
    ds_read_b128 v[132:135], v0 offset:6176
    v_fmac_f32 v50, v35, v79
    v_mfma_f32_16x16x32_bf16 v[160:163], v[96:99], v[116:119], v[160:163]
    buffer_load_dwordx4 v5, s[28:31], s56 offen offset:1024  lds
    s_add_u32 m0, s54, 61920
    v_add_u32_dpp v7, v207, v6 quad_perm:[2,2,2,2] row_mask:0xf bank_mask:0xf
    v_mfma_f32_16x16x32_bf16 v[32:35], v[184:187], a[156:159], 0
    ds_read_b64_tr_b16 v[106:107], v2 offset:33792
    v_fmac_f32 v50, v36, v68
    v_mfma_f32_16x16x32_bf16 v[156:159], v[92:95], v[116:119], v[156:159]
    ds_read_b128 v[136:139], v0 offset:7200
    v_fmac_f32 v50, v37, v69
    v_fmac_f32 v50, v38, v70
    v_fmac_f32 v50, v39, v71
    v_mfma_f32_16x16x32_bf16 v[36:39], a[156:159], a[156:159], 0
    v_fmac_f32 v50, v28, v72
    v_fmac_f32 v50, v29, v73
    v_mfma_f32_16x16x32_bf16 v[164:167], v[92:95], v[120:123], v[164:167]
    buffer_load_dwordx4 v7, s[24:27], 0 offen  lds
    s_add_u32 m0, s54, 66048
    v_add_u32_dpp v7, v204, v6 quad_perm:[3,3,3,3] row_mask:0xf bank_mask:0xf
    v_fmac_f32 v50, v30, v74
    v_fmac_f32 v50, v31, v75
    v_mfma_f32_16x16x32_bf16 v[28:31], a[28:31], a[156:159], 0
    buffer_load_dwordx4 v7, s[24:27], 0 offen  lds
    v_fmac_f32 v51, v33, v61
    v_mfma_f32_16x16x32_bf16 v[168:171], v[96:99], v[120:123], v[168:171]
    v_fmac_f32 v51, v36, v76
    v_fmac_f32 v51, v37, v77
    v_mfma_f32_16x16x32_bf16 v[32:35], a[92:95], a[156:159], 0
    v_fmac_f32 v51, v38, v78
    v_fmac_f32 v51, v39, v79
L_step49:
    s_waitcnt vmcnt(8) lgkmcnt(0)
    v_mfma_f32_16x16x32_bf16 v[140:143], v[100:103], v[124:127], v[140:143]
    s_barrier
    ds_read_b64_tr_b16 v[92:93], v4 offset:0
    ds_read_b128 v[108:111], v0 offset:8256
    s_add_u32 m0, s55, 24576
    s_mov_b32 s56, 401408
    v_mfma_f32_16x16x32_bf16 v[148:151], v[100:103], v[128:131], v[148:151]
    buffer_load_dwordx4 v5, s[28:31], s56 offen  lds
    v_fmac_f32 v51, v28, v68
    v_mfma_f32_16x16x32_bf16 v[152:155], v[104:107], v[128:131], v[152:155]
    ds_read_b64_tr_b16 v[94:95], v4 offset:1024
    v_fmac_f32 v51, v29, v69
    v_mfma_f32_16x16x32_bf16 v[144:147], v[104:107], v[124:127], v[144:147]
    ds_read_b128 v[112:115], v0 offset:9280
    v_fmac_f32 v51, v30, v70
    v_mfma_f32_16x16x32_bf16 v[36:39], v[172:175], a[160:163], 0
    ds_read_b128 v[80:83], v12 offset:9216
    ds_read_b64_tr_b16 v[96:97], v2 offset:0
    v_mfma_f32_16x16x32_bf16 v[160:163], v[104:107], v[132:135], v[160:163]
    buffer_load_dwordx4 v5, s[28:31], s56 offen offset:1024  lds
    s_add_u32 m0, s54, 70176
    v_add_u32_dpp v7, v205, v6 quad_perm:[3,3,3,3] row_mask:0xf bank_mask:0xf
    v_fmac_f32 v51, v31, v71
    v_mfma_f32_16x16x32_bf16 v[28:31], a[160:163], a[160:163], 0
    ds_read_b128 v[116:119], v0 offset:10304
    v_fmac_f32 v51, v32, v72
    v_mfma_f32_16x16x32_bf16 v[156:159], v[100:103], v[132:135], v[156:159]
    ds_read_b64_tr_b16 v[98:99], v2 offset:1024
    v_fmac_f32 v51, v33, v73
    v_fmac_f32 v51, v34, v74
    v_fmac_f32 v51, v35, v75
    v_mfma_f32_16x16x32_bf16 v[32:35], a[32:35], a[160:163], 0
    buffer_load_dwordx4 v7, s[24:27], 0 offen  lds
    v_fmac_f32 v52, v38, v61
    v_mfma_f32_16x16x32_bf16 v[164:167], v[100:103], v[136:139], v[164:167]
    ds_read_b128 v[120:123], v0 offset:11328
    v_fmac_f32 v52, v28, v76
    v_mfma_f32_16x16x32_bf16 v[36:39], a[96:99], a[160:163], 0
    v_fmac_f32 v52, v29, v77
    v_fmac_f32 v52, v30, v78
    v_mfma_f32_16x16x32_bf16 v[168:171], v[104:107], v[136:139], v[168:171]
    v_fmac_f32 v52, v31, v79
    v_fmac_f32 v52, v32, v68
    v_mfma_f32_16x16x32_bf16 v[28:31], v[176:179], a[164:167], 0
    v_fmac_f32 v52, v33, v69
    v_fmac_f32 v52, v34, v70
L_step50:
    s_waitcnt vmcnt(8) lgkmcnt(0)
    v_mfma_f32_16x16x32_bf16 v[140:143], v[92:95], v[108:111], v[140:143]
    s_barrier
    ds_read_b64_tr_b16 v[100:101], v4 offset:8192
    ds_read_b128 v[124:127], v0 offset:12384
    s_add_u32 m0, s55, 32768
    s_mov_b32 s56, 409600
    v_mfma_f32_16x16x32_bf16 v[148:151], v[92:95], v[112:115], v[148:151]
    buffer_load_dwordx4 v5, s[28:31], s56 offen  lds
    ds_read_b64_tr_b16 v[102:103], v4 offset:9216
    v_mfma_f32_16x16x32_bf16 v[152:155], v[96:99], v[112:115], v[152:155]
    ds_read_b128 v[128:131], v0 offset:13408
    ds_read_b64_tr_b16 v[104:105], v2 offset:8192
    v_mfma_f32_16x16x32_bf16 v[144:147], v[96:99], v[108:111], v[144:147]
    ds_read_b128 v[132:135], v0 offset:14432
    v_fmac_f32 v52, v35, v71
    v_mfma_f32_16x16x32_bf16 v[32:35], a[164:167], a[164:167], 0
    ds_read_b64_tr_b16 v[106:107], v2 offset:9216
    v_fmac_f32 v52, v36, v72
    v_mfma_f32_16x16x32_bf16 v[160:163], v[96:99], v[116:119], v[160:163]
    buffer_load_dwordx4 v5, s[28:31], s56 offen offset:1024  lds
    s_add_u32 m0, s54, 74304
    v_add_u32_dpp v7, v206, v6 quad_perm:[3,3,3,3] row_mask:0xf bank_mask:0xf
    v_mfma_f32_16x16x32_bf16 v[156:159], v[92:95], v[116:119], v[156:159]
    ds_read_b128 v[136:139], v0 offset:15456
    v_fmac_f32 v52, v37, v73
    v_fmac_f32 v52, v38, v74
    v_fmac_f32 v52, v39, v75
    v_mfma_f32_16x16x32_bf16 v[36:39], a[36:39], a[164:167], 0
    v_fmac_f32 v53, v30, v61
    v_fmac_f32 v53, v32, v76
    v_mfma_f32_16x16x32_bf16 v[164:167], v[92:95], v[120:123], v[164:167]
    v_fmac_f32 v53, v33, v77
    v_fmac_f32 v53, v34, v78
    v_mfma_f32_16x16x32_bf16 v[28:31], a[100:103], a[164:167], 0
    buffer_load_dwordx4 v7, s[24:27], 0 offen  lds
    v_add_u32 v190, L_step58-L_pc, v189
    v_mfma_f32_16x16x32_bf16 v[168:171], v[96:99], v[120:123], v[168:171]
    global_load_dword v190, v190, s[62:63]
    v_fmac_f32 v53, v35, v79
    v_mfma_f32_16x16x32_bf16 v[32:35], v[180:183], a[168:171], 0
    v_fmac_f32 v53, v36, v68
    v_fmac_f32 v53, v37, v69
L_step51:
    s_waitcnt vmcnt(9) lgkmcnt(0)
    v_mfma_f32_16x16x32_bf16 v[140:143], v[100:103], v[124:127], v[140:143]
    s_barrier
    ds_read_b64_tr_b16 v[92:93], v4 offset:16384
    ds_read_b128 v[108:111], v0 offset:16512
    s_add_u32 m0, s55, 0
    s_mov_b32 s56, 417792
    v_mfma_f32_16x16x32_bf16 v[148:151], v[100:103], v[128:131], v[148:151]
    buffer_load_dwordx4 v5, s[28:31], s56 offen  lds
    v_fmac_f32 v53, v38, v70
    v_mfma_f32_16x16x32_bf16 v[152:155], v[104:107], v[128:131], v[152:155]
    ds_read_b64_tr_b16 v[94:95], v4 offset:17408
    v_fmac_f32 v53, v39, v71
    v_mfma_f32_16x16x32_bf16 v[144:147], v[104:107], v[124:127], v[144:147]
    ds_read_b128 v[112:115], v0 offset:17536
    v_fmac_f32 v53, v28, v72
    v_mfma_f32_16x16x32_bf16 v[36:39], a[168:171], a[168:171], 0
    ds_read_b64_tr_b16 v[96:97], v2 offset:16384
    v_fmac_f32 v53, v29, v73
    v_mfma_f32_16x16x32_bf16 v[160:163], v[104:107], v[132:135], v[160:163]
    buffer_load_dwordx4 v5, s[28:31], s56 offen offset:1024  lds
    s_add_u32 m0, s54, 78432
    v_add_u32_dpp v7, v207, v6 quad_perm:[3,3,3,3] row_mask:0xf bank_mask:0xf
    v_fmac_f32 v53, v30, v74
    v_fmac_f32 v53, v31, v75
    v_mfma_f32_16x16x32_bf16 v[28:31], a[40:43], a[168:171], 0
    ds_read_b128 v[116:119], v0 offset:18560
    v_fmac_f32 v54, v34, v61
    v_mfma_f32_16x16x32_bf16 v[156:159], v[100:103], v[132:135], v[156:159]
    ds_read_b64_tr_b16 v[98:99], v2 offset:17408
    v_fmac_f32 v54, v36, v76
    v_mfma_f32_16x16x32_bf16 v[32:35], a[104:107], a[168:171], 0
    ds_read_b128 v[120:123], v0 offset:19584
    v_fmac_f32 v54, v37, v77
    v_mfma_f32_16x16x32_bf16 v[164:167], v[100:103], v[136:139], v[164:167]
    buffer_load_dwordx4 v7, s[24:27], 0 offen  lds
    v_fmac_f32 v54, v38, v78
    v_fmac_f32 v54, v39, v79
    v_mfma_f32_16x16x32_bf16 v[36:39], v[184:187], a[172:175], 0
    v_fmac_f32 v54, v28, v68
    v_fmac_f32 v54, v29, v69
    v_mfma_f32_16x16x32_bf16 v[168:171], v[104:107], v[136:139], v[168:171]
    v_fmac_f32 v54, v30, v70
    v_fmac_f32 v54, v31, v71
    v_mfma_f32_16x16x32_bf16 v[28:31], a[172:175], a[172:175], 0
    v_fmac_f32 v54, v32, v72
    v_fmac_f32 v54, v33, v73
L_step52:
    s_waitcnt vmcnt(8) lgkmcnt(0)
    v_mfma_f32_16x16x32_bf16 v[140:143], v[92:95], v[108:111], v[140:143]
    s_barrier
    ds_read_b64_tr_b16 v[100:101], v4 offset:24576
    ds_read_b128 v[124:127], v0 offset:20640
    s_add_u32 m0, s55, 8192
    s_mov_b32 s56, 425984
    v_mfma_f32_16x16x32_bf16 v[148:151], v[92:95], v[112:115], v[148:151]
    buffer_load_dwordx4 v5, s[28:31], s56 offen  lds
    ds_read_b64_tr_b16 v[102:103], v4 offset:25600
    v_mfma_f32_16x16x32_bf16 v[152:155], v[96:99], v[112:115], v[152:155]
    ds_read_b128 v[128:131], v0 offset:21664
    v_fmac_f32 v54, v34, v74
    v_mfma_f32_16x16x32_bf16 v[144:147], v[96:99], v[108:111], v[144:147]
    ds_read_b64_tr_b16 v[104:105], v2 offset:24576
    v_fmac_f32 v54, v35, v75
    v_mfma_f32_16x16x32_bf16 v[32:35], a[44:47], a[172:175], 0
    ds_read_b128 v[132:135], v0 offset:22688
    v_fmac_f32 v55, v38, v61
    v_mfma_f32_16x16x32_bf16 v[160:163], v[96:99], v[116:119], v[160:163]
    buffer_load_dwordx4 v5, s[28:31], s56 offen offset:1024  lds
    s_add_u32 m0, s54, 82560
    v_add_u32_dpp v7, v208, v6 quad_perm:[0,0,0,0] row_mask:0xf bank_mask:0xf
    v_mfma_f32_16x16x32_bf16 v[156:159], v[92:95], v[116:119], v[156:159]
    ds_read_b64_tr_b16 v[106:107], v2 offset:25600
    v_fmac_f32 v55, v28, v76
    v_mfma_f32_16x16x32_bf16 v[36:39], a[108:111], a[172:175], 0
    ds_read_b128 v[136:139], v0 offset:23712
    v_fmac_f32 v55, v29, v77
    v_mfma_f32_16x16x32_bf16 v[164:167], v[92:95], v[120:123], v[164:167]
    v_fmac_f32 v55, v30, v78
    v_fmac_f32 v55, v31, v79
    v_mfma_f32_16x16x32_bf16 v[28:31], v[172:175], a[176:179], 0
    buffer_load_dwordx4 v7, s[24:27], 0 offen  lds
    v_fmac_f32 v55, v32, v68
    v_mfma_f32_16x16x32_bf16 v[168:171], v[96:99], v[120:123], v[168:171]
    v_fmac_f32 v55, v33, v69
    v_fmac_f32 v55, v34, v70
    v_fmac_f32 v55, v35, v71
    v_mfma_f32_16x16x32_bf16 v[32:35], a[176:179], a[176:179], 0
    v_fmac_f32 v55, v36, v72
    v_fmac_f32 v55, v37, v73
L_step53:
    s_waitcnt vmcnt(8) lgkmcnt(0)
    v_mfma_f32_16x16x32_bf16 v[140:143], v[100:103], v[124:127], v[140:143]
    s_barrier
    ds_read_b64_tr_b16 v[92:93], v4 offset:32768
    ds_read_b128 v[108:111], v0 offset:24768
    s_add_u32 m0, s55, 16384
    s_mov_b32 s56, 434176
    v_mfma_f32_16x16x32_bf16 v[148:151], v[100:103], v[128:131], v[148:151]
    buffer_load_dwordx4 v5, s[28:31], s56 offen  lds
    v_fmac_f32 v55, v38, v74
    v_mfma_f32_16x16x32_bf16 v[152:155], v[104:107], v[128:131], v[152:155]
    ds_read_b64_tr_b16 v[94:95], v4 offset:33792
    v_fmac_f32 v55, v39, v75
    v_mfma_f32_16x16x32_bf16 v[144:147], v[104:107], v[124:127], v[144:147]
    ds_read_b128 v[112:115], v0 offset:25792
    v_fmac_f32 v56, v31, v61
    v_mfma_f32_16x16x32_bf16 v[36:39], a[48:51], a[176:179], 0
    ds_read_b64_tr_b16 v[96:97], v2 offset:32768
    v_fmac_f32 v56, v32, v76
    v_mfma_f32_16x16x32_bf16 v[160:163], v[104:107], v[132:135], v[160:163]
    buffer_load_dwordx4 v5, s[28:31], s56 offen offset:1024  lds
    s_add_u32 m0, s54, 86688
    v_add_u32_dpp v7, v209, v6 quad_perm:[0,0,0,0] row_mask:0xf bank_mask:0xf
    v_mfma_f32_16x16x32_bf16 v[28:31], a[112:115], a[176:179], 0
    ds_read_b128 v[116:119], v0 offset:26816
    v_fmac_f32 v56, v33, v77
    v_mfma_f32_16x16x32_bf16 v[156:159], v[100:103], v[132:135], v[156:159]
    ds_read_b64_tr_b16 v[98:99], v2 offset:33792
    v_fmac_f32 v56, v34, v78
    v_fmac_f32 v56, v35, v79
    v_mfma_f32_16x16x32_bf16 v[32:35], v[176:179], a[180:183], 0
    ds_read_b128 v[120:123], v0 offset:27840
    v_fmac_f32 v56, v36, v68
    v_mfma_f32_16x16x32_bf16 v[164:167], v[100:103], v[136:139], v[164:167]
    buffer_load_dwordx4 v7, s[24:27], 0 offen  lds
    v_fmac_f32 v56, v37, v69
    v_fmac_f32 v56, v38, v70
    v_fmac_f32 v56, v39, v71
    v_mfma_f32_16x16x32_bf16 v[36:39], a[180:183], a[180:183], 0
    v_fmac_f32 v56, v28, v72
    v_fmac_f32 v56, v29, v73
    v_mfma_f32_16x16x32_bf16 v[168:171], v[104:107], v[136:139], v[168:171]
    v_fmac_f32 v56, v30, v74
    v_fmac_f32 v56, v31, v75
    v_mfma_f32_16x16x32_bf16 v[28:31], a[52:55], a[180:183], 0
    v_fmac_f32 v57, v35, v61
    v_and_b32 v63, 0xffff0000, v64
L_step54:
    s_waitcnt vmcnt(7) lgkmcnt(0)
    v_mfma_f32_16x16x32_bf16 v[140:143], v[92:95], v[108:111], v[140:143]
    s_barrier
    ds_read_b64_tr_b16 v[100:101], v4 offset:0
    ds_read_b128 v[124:127], v0 offset:28896
    s_add_u32 m0, s55, 24576
    s_mov_b32 s56, 442368
    v_mfma_f32_16x16x32_bf16 v[148:151], v[92:95], v[112:115], v[148:151]
    buffer_load_dwordx4 v5, s[28:31], s56 offen  lds
    ds_read_b64_tr_b16 v[102:103], v4 offset:1024
    v_mfma_f32_16x16x32_bf16 v[152:155], v[96:99], v[112:115], v[152:155]
    ds_read_b128 v[128:131], v0 offset:29920
    v_fmac_f32 v57, v36, v76
    v_mfma_f32_16x16x32_bf16 v[144:147], v[96:99], v[108:111], v[144:147]
    ds_read_b64_tr_b16 v[104:105], v2 offset:0
    v_fmac_f32 v57, v37, v77
    v_mfma_f32_16x16x32_bf16 v[32:35], a[116:119], a[180:183], 0
    ds_read_b128 v[132:135], v0 offset:30944
    v_fmac_f32 v57, v38, v78
    v_mfma_f32_16x16x32_bf16 v[160:163], v[96:99], v[116:119], v[160:163]
    buffer_load_dwordx4 v5, s[28:31], s56 offen offset:1024  lds
    s_add_u32 m0, s54, 90816
    v_add_u32_dpp v7, v210, v6 quad_perm:[0,0,0,0] row_mask:0xf bank_mask:0xf
    v_mfma_f32_16x16x32_bf16 v[156:159], v[92:95], v[116:119], v[156:159]
    ds_read_b64_tr_b16 v[106:107], v2 offset:1024
    v_fmac_f32 v57, v39, v79
    v_mfma_f32_16x16x32_bf16 v[36:39], v[180:183], a[184:187], 0
    ds_read_b128 v[136:139], v0 offset:31968
    v_fmac_f32 v57, v28, v68
    v_mfma_f32_16x16x32_bf16 v[164:167], v[92:95], v[120:123], v[164:167]
    v_fmac_f32 v57, v29, v69
    v_fmac_f32 v57, v30, v70
    v_fmac_f32 v57, v31, v71
    v_mfma_f32_16x16x32_bf16 v[28:31], a[184:187], a[184:187], 0
    buffer_load_dwordx4 v7, s[24:27], 0 offen  lds
    v_fmac_f32 v57, v32, v72
    v_mfma_f32_16x16x32_bf16 v[168:171], v[96:99], v[120:123], v[168:171]
    v_fmac_f32 v57, v33, v73
    v_fmac_f32 v57, v34, v74
    v_fmac_f32 v57, v35, v75
    v_mfma_f32_16x16x32_bf16 v[32:35], a[56:59], a[184:187], 0
    v_fmac_f32 v58, v39, v61
    v_fmac_f32 v58, v28, v76
L_step55:
    s_waitcnt vmcnt(7) lgkmcnt(0)
    v_mfma_f32_16x16x32_bf16 v[140:143], v[100:103], v[124:127], v[140:143]
    s_barrier
    ds_read_b64_tr_b16 v[92:93], v4 offset:8192
    ds_read_b128 v[108:111], v0 offset:33024
    s_add_u32 m0, s55, 32768
    s_mov_b32 s56, 450560
    v_add_u32 v9, 16512, v8
    v_xad_u32 v10, v11, 0, v9
    v_mfma_f32_16x16x32_bf16 v[148:151], v[100:103], v[128:131], v[148:151]
    ds_read_b128 a[192:195], v10 offset:0
    ds_read_b128 a[196:199], v10 offset:64
    v_mfma_f32_16x16x32_bf16 v[152:155], v[104:107], v[128:131], v[152:155]
    ds_read_b128 a[200:203], v10 offset:128
    buffer_load_dwordx4 v5, s[28:31], s56 offen  lds
    v_mfma_f32_16x16x32_bf16 v[144:147], v[104:107], v[124:127], v[144:147]
    ds_read_b128 a[204:207], v10 offset:192
    ds_read_b64_tr_b16 v[94:95], v4 offset:9216
    v_mfma_f32_16x16x32_bf16 v[36:39], a[120:123], a[184:187], 0
    ds_read_b128 v[112:115], v0 offset:34048
    v_fmac_f32 v58, v29, v77
    v_mfma_f32_16x16x32_bf16 v[160:163], v[104:107], v[132:135], v[160:163]
    ds_read_b64_tr_b16 v[96:97], v2 offset:8192
    ds_read_b128 v[116:119], v0 offset:35072
    v_fmac_f32 v58, v30, v78
    v_fmac_f32 v58, v31, v79
    v_mfma_f32_16x16x32_bf16 v[28:31], v[184:187], a[188:191], 0
    buffer_load_dwordx4 v5, s[28:31], s56 offen offset:1024  lds
    s_add_u32 m0, s54, 94944
    v_add_u32_dpp v7, v211, v6 quad_perm:[0,0,0,0] row_mask:0xf bank_mask:0xf
    v_mfma_f32_16x16x32_bf16 v[156:159], v[100:103], v[132:135], v[156:159]
    ds_read_b64_tr_b16 v[98:99], v2 offset:9216
    v_fmac_f32 v58, v32, v68
    v_fmac_f32 v58, v33, v69
    v_fmac_f32 v58, v34, v70
    v_fmac_f32 v58, v35, v71
    v_mfma_f32_16x16x32_bf16 v[32:35], a[188:191], a[188:191], 0
    ds_read_b128 v[120:123], v0 offset:36096
    v_fmac_f32 v58, v36, v72
    v_mfma_f32_16x16x32_bf16 v[164:167], v[100:103], v[136:139], v[164:167]
    buffer_load_dwordx4 v7, s[24:27], 0 offen  lds
    v_fmac_f32 v58, v37, v73
    v_fmac_f32 v58, v38, v74
    v_fmac_f32 v58, v39, v75
    v_mfma_f32_16x16x32_bf16 v[36:39], a[60:63], a[188:191], 0
    v_fmac_f32 v59, v31, v61
    v_fmac_f32 v59, v32, v76
    v_mfma_f32_16x16x32_bf16 v[168:171], v[104:107], v[136:139], v[168:171]
    v_fmac_f32 v59, v33, v77
    v_fmac_f32 v59, v34, v78
    v_mfma_f32_16x16x32_bf16 v[28:31], a[124:127], a[188:191], 0
    v_fmac_f32 v59, v35, v79
    v_lshlrev_b32 v64, 16, v65
L_step56:
    s_waitcnt vmcnt(7) lgkmcnt(0)
    v_mfma_f32_16x16x32_bf16 v[140:143], v[92:95], v[108:111], v[140:143]
    s_barrier
    ds_read_b128 v[76:79], v12 offset:8192
    ds_read_b64_tr_b16 v[100:101], v4 offset:16384
    s_add_u32 m0, s55, 0
    s_mov_b32 s56, 458752
    v_xad_u32 v10, v11, 48, v9
    v_mfma_f32_16x16x32_bf16 v[148:151], v[92:95], v[112:115], v[148:151]
    ds_read_b128 a[208:211], v10 offset:256
    ds_read_b128 a[212:215], v10 offset:320
    v_mfma_f32_16x16x32_bf16 v[152:155], v[96:99], v[112:115], v[152:155]
    ds_read_b128 a[216:219], v10 offset:384
    buffer_load_dwordx4 v5, s[28:31], s56 offen  lds
    v_mfma_f32_16x16x32_bf16 v[144:147], v[96:99], v[108:111], v[144:147]
    ds_read_b128 a[220:223], v10 offset:448
    ds_read_b128 v[124:127], v0 offset:37152
    v_mfma_f32_16x16x32_bf16 v[32:35], v[172:175], a[192:195], 0
    v_fmac_f32 v59, v36, v68
    v_fmac_f32 v59, v37, v69
    v_mfma_f32_16x16x32_bf16 v[160:163], v[96:99], v[116:119], v[160:163]
    ds_read_b64_tr_b16 v[102:103], v4 offset:17408
    ds_read_b128 v[128:131], v0 offset:38176
    v_fmac_f32 v59, v38, v70
    v_fmac_f32 v59, v39, v71
    v_mfma_f32_16x16x32_bf16 v[36:39], a[192:195], a[192:195], 0
    ds_read_b128 v[68:71], v12 offset:6144
    buffer_load_dwordx4 v5, s[28:31], s56 offen offset:1024  lds
    s_add_u32 m0, s54, 0
    v_add_u32_dpp v7, v208, v6 quad_perm:[1,1,1,1] row_mask:0xf bank_mask:0xf
    v_mfma_f32_16x16x32_bf16 v[156:159], v[92:95], v[116:119], v[156:159]
    ds_read_b64_tr_b16 v[104:105], v2 offset:16384
    ds_read_b128 v[132:135], v0 offset:39200
    v_fmac_f32 v59, v28, v72
    v_fmac_f32 v59, v29, v73
    v_fmac_f32 v59, v30, v74
    v_fmac_f32 v59, v31, v75
    v_mfma_f32_16x16x32_bf16 v[28:31], a[0:3], a[192:195], 0
    ds_read_b128 v[72:75], v12 offset:7168
    ds_read_b64_tr_b16 v[106:107], v2 offset:17408
    v_mfma_f32_16x16x32_bf16 v[164:167], v[92:95], v[120:123], v[164:167]
    buffer_load_dwordx4 v7, s[24:27], 0 offen  lds
    ds_read_b128 v[136:139], v0 offset:40224
    v_fmac_f32 v44, v32, v60
    v_mfma_f32_16x16x32_bf16 v[32:35], a[64:67], a[192:195], 0
    v_fmac_f32 v44, v36, v80
    v_fmac_f32 v44, v37, v81
    v_mfma_f32_16x16x32_bf16 v[168:171], v[96:99], v[120:123], v[168:171]
    v_fmac_f32 v44, v38, v82
    v_fmac_f32 v44, v39, v83
    v_mfma_f32_16x16x32_bf16 v[36:39], a[128:131], a[192:195], 0
    s_waitcnt lgkmcnt(5)
    v_fmac_f32 v44, v28, v68
L_step57:
    s_waitcnt vmcnt(7) lgkmcnt(0)
    v_mfma_f32_16x16x32_bf16 v[140:143], v[100:103], v[124:127], v[140:143]
    s_barrier
    ds_read_b64_tr_b16 v[92:93], v4 offset:24576
    ds_read_b128 v[108:111], v0 offset:41280
    s_add_u32 m0, s55, 8192
    s_mov_b32 s56, 466944
    v_xad_u32 v10, v11, 32, v9
    v_mfma_f32_16x16x32_bf16 v[148:151], v[100:103], v[128:131], v[148:151]
    ds_read_b128 a[224:227], v10 offset:512
    ds_read_b128 a[228:231], v10 offset:576
    v_mfma_f32_16x16x32_bf16 v[152:155], v[104:107], v[128:131], v[152:155]
    ds_read_b128 a[232:235], v10 offset:640
    buffer_load_dwordx4 v5, s[28:31], s56 offen  lds
    v_mfma_f32_16x16x32_bf16 v[144:147], v[104:107], v[124:127], v[144:147]
    ds_read_b128 a[236:239], v10 offset:704
    ds_read_b64_tr_b16 v[94:95], v4 offset:25600
    v_fmac_f32 v44, v29, v69
    v_fmac_f32 v44, v30, v70
    v_fmac_f32 v44, v31, v71
    v_mfma_f32_16x16x32_bf16 v[28:31], v[176:179], a[196:199], 0
    ds_read_b128 v[112:115], v0 offset:42304
    ds_read_b64_tr_b16 v[96:97], v2 offset:24576
    v_mfma_f32_16x16x32_bf16 v[160:163], v[104:107], v[132:135], v[160:163]
    ds_read_b128 v[116:119], v0 offset:43328
    v_fmac_f32 v44, v32, v72
    v_fmac_f32 v44, v33, v73
    v_fmac_f32 v44, v34, v74
    v_fmac_f32 v44, v35, v75
    v_mfma_f32_16x16x32_bf16 v[32:35], a[196:199], a[196:199], 0
    buffer_load_dwordx4 v5, s[28:31], s56 offen offset:1024  lds
    s_add_u32 m0, s54, 4128
    v_add_u32_dpp v7, v209, v6 quad_perm:[1,1,1,1] row_mask:0xf bank_mask:0xf
    v_mfma_f32_16x16x32_bf16 v[156:159], v[100:103], v[132:135], v[156:159]
    ds_read_b64_tr_b16 v[98:99], v2 offset:25600
    v_fmac_f32 v44, v36, v76
    v_fmac_f32 v44, v37, v77
    v_fmac_f32 v44, v38, v78
    v_fmac_f32 v44, v39, v79
    v_mfma_f32_16x16x32_bf16 v[36:39], a[4:7], a[196:199], 0
    ds_read_b128 v[120:123], v0 offset:44352
    v_fmac_f32 v45, v28, v60
    v_mfma_f32_16x16x32_bf16 v[164:167], v[100:103], v[136:139], v[164:167]
    buffer_load_dwordx4 v7, s[24:27], 0 offen  lds
    v_fmac_f32 v45, v32, v80
    v_mfma_f32_16x16x32_bf16 v[28:31], a[68:71], a[196:199], 0
    v_fmac_f32 v45, v33, v81
    v_fmac_f32 v45, v34, v82
    v_mfma_f32_16x16x32_bf16 v[168:171], v[104:107], v[136:139], v[168:171]
    v_fmac_f32 v45, v35, v83
    v_fmac_f32 v45, v36, v68
    v_mfma_f32_16x16x32_bf16 v[32:35], a[132:135], a[196:199], 0
    v_fmac_f32 v45, v37, v69
    v_fmac_f32 v45, v38, v70
L_step58:
    s_waitcnt vmcnt(7) lgkmcnt(0)
    v_mfma_f32_16x16x32_bf16 v[140:143], v[92:95], v[108:111], v[140:143]
    s_barrier
    ds_read_b64_tr_b16 v[100:101], v4 offset:32768
    ds_read_b128 v[124:127], v0 offset:45408
    s_add_u32 m0, s55, 16384
    s_mov_b32 s56, 475136
    v_xad_u32 v10, v11, 16, v9
    v_mfma_f32_16x16x32_bf16 v[148:151], v[92:95], v[112:115], v[148:151]
    ds_read_b128 a[240:243], v10 offset:768
    ds_read_b128 a[244:247], v10 offset:832
    v_mfma_f32_16x16x32_bf16 v[152:155], v[96:99], v[112:115], v[152:155]
    ds_read_b128 a[248:251], v10 offset:896
    buffer_load_dwordx4 v5, s[28:31], s56 offen  lds
    v_mfma_f32_16x16x32_bf16 v[144:147], v[96:99], v[108:111], v[144:147]
    ds_read_b128 a[252:255], v10 offset:960
    ds_read_b64_tr_b16 v[102:103], v4 offset:33792
    v_fmac_f32 v45, v39, v71
    v_mfma_f32_16x16x32_bf16 v[36:39], v[180:183], a[200:203], 0
    ds_read_b128 v[128:131], v0 offset:46432
    v_fmac_f32 v45, v28, v72
    v_mfma_f32_16x16x32_bf16 v[160:163], v[96:99], v[116:119], v[160:163]
    ds_read_b64_tr_b16 v[104:105], v2 offset:32768
    ds_read_b128 v[132:135], v0 offset:47456
    v_fmac_f32 v45, v29, v73
    v_fmac_f32 v45, v30, v74
    v_fmac_f32 v45, v31, v75
    v_mfma_f32_16x16x32_bf16 v[28:31], a[200:203], a[200:203], 0
    buffer_load_dwordx4 v5, s[28:31], s56 offen offset:1024  lds
    s_add_u32 m0, s54, 8256
    v_add_u32_dpp v7, v210, v6 quad_perm:[1,1,1,1] row_mask:0xf bank_mask:0xf
    v_mfma_f32_16x16x32_bf16 v[156:159], v[92:95], v[116:119], v[156:159]
    ds_read_b64_tr_b16 v[106:107], v2 offset:33792
    v_fmac_f32 v45, v32, v76
    v_fmac_f32 v45, v33, v77
    v_fmac_f32 v45, v34, v78
    v_fmac_f32 v45, v35, v79
    v_mfma_f32_16x16x32_bf16 v[32:35], a[8:11], a[200:203], 0
    ds_read_b128 v[136:139], v0 offset:48480
    v_fmac_f32 v46, v36, v60
    v_mfma_f32_16x16x32_bf16 v[164:167], v[92:95], v[120:123], v[164:167]
    buffer_load_dwordx4 v7, s[24:27], 0 offen  lds
    v_fmac_f32 v46, v28, v80
    v_mfma_f32_16x16x32_bf16 v[36:39], a[72:75], a[200:203], 0
    v_fmac_f32 v46, v29, v81
    v_fmac_f32 v46, v30, v82
    v_mfma_f32_16x16x32_bf16 v[168:171], v[96:99], v[120:123], v[168:171]
    v_fmac_f32 v46, v31, v83
    v_fmac_f32 v46, v32, v68
    v_mfma_f32_16x16x32_bf16 v[28:31], a[136:139], a[200:203], 0
    v_fmac_f32 v46, v33, v69
    v_fmac_f32 v46, v34, v70
L_step59:
    s_waitcnt vmcnt(7) lgkmcnt(0)
    v_mfma_f32_16x16x32_bf16 v[140:143], v[100:103], v[124:127], v[140:143]
    s_barrier
    ds_read_b64_tr_b16 v[92:93], v4 offset:0
    ds_read_b128 v[108:111], v1 offset:0
    s_add_u32 m0, s55, 24576
    s_mov_b32 s56, 483328
    v_mfma_f32_16x16x32_bf16 v[148:151], v[100:103], v[128:131], v[148:151]
    buffer_load_dwordx4 v5, s[28:31], s56 offen  lds
    v_fmac_f32 v46, v35, v71
    v_mfma_f32_16x16x32_bf16 v[152:155], v[104:107], v[128:131], v[152:155]
    ds_read_b64_tr_b16 v[94:95], v4 offset:1024
    v_fmac_f32 v46, v36, v72
    v_mfma_f32_16x16x32_bf16 v[144:147], v[104:107], v[124:127], v[144:147]
    ds_read_b128 v[112:115], v1 offset:1024
    v_fmac_f32 v46, v37, v73
    v_mfma_f32_16x16x32_bf16 v[32:35], v[184:187], a[204:207], 0
    ds_read_b64_tr_b16 v[96:97], v2 offset:0
    v_fmac_f32 v46, v38, v74
    v_mfma_f32_16x16x32_bf16 v[160:163], v[104:107], v[132:135], v[160:163]
    buffer_load_dwordx4 v5, s[28:31], s56 offen offset:1024  lds
    s_add_u32 m0, s54, 12384
    v_add_u32_dpp v7, v211, v6 quad_perm:[1,1,1,1] row_mask:0xf bank_mask:0xf
    v_fmac_f32 v46, v39, v75
    v_mfma_f32_16x16x32_bf16 v[36:39], a[204:207], a[204:207], 0
    ds_read_b128 v[116:119], v1 offset:2048
    v_fmac_f32 v46, v28, v76
    v_mfma_f32_16x16x32_bf16 v[156:159], v[100:103], v[132:135], v[156:159]
    ds_read_b64_tr_b16 v[98:99], v2 offset:1024
    v_fmac_f32 v46, v29, v77
    v_fmac_f32 v46, v30, v78
    v_fmac_f32 v46, v31, v79
    v_mfma_f32_16x16x32_bf16 v[28:31], a[12:15], a[204:207], 0
    buffer_load_dwordx4 v7, s[24:27], 0 offen  lds
    v_fmac_f32 v47, v32, v60
    v_mfma_f32_16x16x32_bf16 v[164:167], v[100:103], v[136:139], v[164:167]
    ds_read_b128 v[120:123], v1 offset:3072
    v_fmac_f32 v47, v36, v80
    v_mfma_f32_16x16x32_bf16 v[32:35], a[76:79], a[204:207], 0
    v_fmac_f32 v47, v37, v81
    v_fmac_f32 v47, v38, v82
    v_mfma_f32_16x16x32_bf16 v[168:171], v[104:107], v[136:139], v[168:171]
    v_fmac_f32 v47, v39, v83
    v_fmac_f32 v47, v28, v68
    v_mfma_f32_16x16x32_bf16 v[36:39], a[140:143], a[204:207], 0
    v_fmac_f32 v47, v29, v69
    v_fmac_f32 v47, v30, v70
L_step60:
    s_waitcnt vmcnt(7) lgkmcnt(0)
    v_mfma_f32_16x16x32_bf16 v[140:143], v[92:95], v[108:111], v[140:143]
    s_barrier
    ds_read_b64_tr_b16 v[100:101], v4 offset:8192
    ds_read_b128 v[124:127], v1 offset:4128
    s_add_u32 m0, s55, 32768
    s_mov_b32 s56, 491520
    v_mfma_f32_16x16x32_bf16 v[148:151], v[92:95], v[112:115], v[148:151]
    buffer_load_dwordx4 v5, s[28:31], s56 offen  lds
    ds_read_b64_tr_b16 v[102:103], v4 offset:9216
    v_mfma_f32_16x16x32_bf16 v[152:155], v[96:99], v[112:115], v[152:155]
    ds_read_b128 v[128:131], v1 offset:5152
    v_fmac_f32 v47, v31, v71
    v_mfma_f32_16x16x32_bf16 v[144:147], v[96:99], v[108:111], v[144:147]
    ds_read_b64_tr_b16 v[104:105], v2 offset:8192
    v_fmac_f32 v47, v32, v72
    v_mfma_f32_16x16x32_bf16 v[28:31], v[172:175], a[208:211], 0
    ds_read_b128 v[132:135], v1 offset:6176
    v_fmac_f32 v47, v33, v73
    v_mfma_f32_16x16x32_bf16 v[160:163], v[96:99], v[116:119], v[160:163]
    buffer_load_dwordx4 v5, s[28:31], s56 offen offset:1024  lds
    s_add_u32 m0, s54, 16512
    v_add_u32_dpp v7, v208, v6 quad_perm:[2,2,2,2] row_mask:0xf bank_mask:0xf
    v_fmac_f32 v47, v34, v74
    v_fmac_f32 v47, v35, v75
    v_mfma_f32_16x16x32_bf16 v[32:35], a[208:211], a[208:211], 0
    ds_read_b64_tr_b16 v[106:107], v2 offset:9216
    v_fmac_f32 v47, v36, v76
    v_mfma_f32_16x16x32_bf16 v[156:159], v[92:95], v[116:119], v[156:159]
    ds_read_b128 v[136:139], v1 offset:7200
    v_fmac_f32 v47, v37, v77
    v_fmac_f32 v47, v38, v78
    v_fmac_f32 v47, v39, v79
    v_mfma_f32_16x16x32_bf16 v[36:39], a[16:19], a[208:211], 0
    buffer_load_dwordx4 v7, s[24:27], 0 offen  lds
    v_add_u32 v190, L_step68-L_pc, v189
    v_mfma_f32_16x16x32_bf16 v[164:167], v[92:95], v[120:123], v[164:167]
    v_fmac_f32 v48, v29, v60
    v_fmac_f32 v48, v32, v80
    v_mfma_f32_16x16x32_bf16 v[28:31], a[80:83], a[208:211], 0
    global_load_dword v190, v190, s[62:63]
    v_fmac_f32 v48, v33, v81
    v_mfma_f32_16x16x32_bf16 v[168:171], v[96:99], v[120:123], v[168:171]
    v_fmac_f32 v48, v34, v82
    v_fmac_f32 v48, v35, v83
    v_mfma_f32_16x16x32_bf16 v[32:35], a[144:147], a[208:211], 0
    v_fmac_f32 v48, v36, v68
    v_fmac_f32 v48, v37, v69
L_step61:
    s_waitcnt vmcnt(8) lgkmcnt(0)
    v_mfma_f32_16x16x32_bf16 v[140:143], v[100:103], v[124:127], v[140:143]
    s_barrier
    ds_read_b64_tr_b16 v[92:93], v4 offset:16384
    ds_read_b128 v[108:111], v1 offset:8256
    s_add_u32 m0, s55, 0
    s_mov_b32 s56, 499712
    v_mfma_f32_16x16x32_bf16 v[148:151], v[100:103], v[128:131], v[148:151]
    buffer_load_dwordx4 v5, s[28:31], s56 offen  lds
    v_fmac_f32 v48, v38, v70
    v_mfma_f32_16x16x32_bf16 v[152:155], v[104:107], v[128:131], v[152:155]
    ds_read_b64_tr_b16 v[94:95], v4 offset:17408
    v_fmac_f32 v48, v39, v71
    v_mfma_f32_16x16x32_bf16 v[144:147], v[104:107], v[124:127], v[144:147]
    ds_read_b128 v[112:115], v1 offset:9280
    v_fmac_f32 v48, v28, v72
    v_mfma_f32_16x16x32_bf16 v[36:39], v[176:179], a[212:215], 0
    ds_read_b64_tr_b16 v[96:97], v2 offset:16384
    v_fmac_f32 v48, v29, v73
    v_mfma_f32_16x16x32_bf16 v[160:163], v[104:107], v[132:135], v[160:163]
    buffer_load_dwordx4 v5, s[28:31], s56 offen offset:1024  lds
    s_add_u32 m0, s54, 20640
    v_add_u32_dpp v7, v209, v6 quad_perm:[2,2,2,2] row_mask:0xf bank_mask:0xf
    v_fmac_f32 v48, v30, v74
    v_fmac_f32 v48, v31, v75
    v_mfma_f32_16x16x32_bf16 v[28:31], a[212:215], a[212:215], 0
    ds_read_b128 v[116:119], v1 offset:10304
    v_fmac_f32 v48, v32, v76
    v_mfma_f32_16x16x32_bf16 v[156:159], v[100:103], v[132:135], v[156:159]
    ds_read_b64_tr_b16 v[98:99], v2 offset:17408
    v_fmac_f32 v48, v33, v77
    v_fmac_f32 v48, v34, v78
    v_fmac_f32 v48, v35, v79
    v_mfma_f32_16x16x32_bf16 v[32:35], a[20:23], a[212:215], 0
    buffer_load_dwordx4 v7, s[24:27], 0 offen  lds
    v_fmac_f32 v49, v37, v60
    v_mfma_f32_16x16x32_bf16 v[164:167], v[100:103], v[136:139], v[164:167]
    ds_read_b128 v[120:123], v1 offset:11328
    v_fmac_f32 v49, v28, v80
    v_mfma_f32_16x16x32_bf16 v[36:39], a[84:87], a[212:215], 0
    v_fmac_f32 v49, v29, v81
    v_fmac_f32 v49, v30, v82
    v_mfma_f32_16x16x32_bf16 v[168:171], v[104:107], v[136:139], v[168:171]
    v_fmac_f32 v49, v31, v83
    v_fmac_f32 v49, v32, v68
    v_mfma_f32_16x16x32_bf16 v[28:31], a[148:151], a[212:215], 0
    v_fmac_f32 v49, v33, v69
    v_fmac_f32 v49, v34, v70
L_step62:
    s_waitcnt vmcnt(8) lgkmcnt(0)
    v_mfma_f32_16x16x32_bf16 v[140:143], v[92:95], v[108:111], v[140:143]
    s_barrier
    ds_read_b64_tr_b16 v[100:101], v4 offset:24576
    ds_read_b128 v[124:127], v1 offset:12384
    s_add_u32 m0, s55, 8192
    s_mov_b32 s56, 507904
    v_mfma_f32_16x16x32_bf16 v[148:151], v[92:95], v[112:115], v[148:151]
    buffer_load_dwordx4 v5, s[28:31], s56 offen  lds
    v_fmac_f32 v49, v35, v71
    v_mfma_f32_16x16x32_bf16 v[152:155], v[96:99], v[112:115], v[152:155]
    ds_read_b64_tr_b16 v[102:103], v4 offset:25600
    v_fmac_f32 v49, v36, v72
    v_mfma_f32_16x16x32_bf16 v[144:147], v[96:99], v[108:111], v[144:147]
    ds_read_b128 v[128:131], v1 offset:13408
    v_fmac_f32 v49, v37, v73
    v_mfma_f32_16x16x32_bf16 v[32:35], v[180:183], a[216:219], 0
    ds_read_b32 v61, v13 offset:1088
    ds_read_b64_tr_b16 v[104:105], v2 offset:24576
    v_mfma_f32_16x16x32_bf16 v[160:163], v[96:99], v[116:119], v[160:163]
    buffer_load_dwordx4 v5, s[28:31], s56 offen offset:1024  lds
    s_add_u32 m0, s54, 24768
    v_add_u32_dpp v7, v210, v6 quad_perm:[2,2,2,2] row_mask:0xf bank_mask:0xf
    v_fmac_f32 v49, v38, v74
    v_fmac_f32 v49, v39, v75
    v_mfma_f32_16x16x32_bf16 v[36:39], a[216:219], a[216:219], 0
    ds_read_b128 v[132:135], v1 offset:14432
    v_fmac_f32 v49, v28, v76
    v_mfma_f32_16x16x32_bf16 v[156:159], v[92:95], v[116:119], v[156:159]
    ds_read_b64_tr_b16 v[106:107], v2 offset:25600
    v_fmac_f32 v49, v29, v77
    v_fmac_f32 v49, v30, v78
    v_fmac_f32 v49, v31, v79
    v_mfma_f32_16x16x32_bf16 v[28:31], a[24:27], a[216:219], 0
    buffer_load_dwordx4 v7, s[24:27], 0 offen  lds
    v_fmac_f32 v50, v33, v60
    v_mfma_f32_16x16x32_bf16 v[164:167], v[92:95], v[120:123], v[164:167]
    ds_read_b128 v[136:139], v1 offset:15456
    v_fmac_f32 v50, v36, v80
    v_mfma_f32_16x16x32_bf16 v[32:35], a[88:91], a[216:219], 0
    v_fmac_f32 v50, v37, v81
    v_fmac_f32 v50, v38, v82
    v_mfma_f32_16x16x32_bf16 v[168:171], v[96:99], v[120:123], v[168:171]
    v_fmac_f32 v50, v39, v83
    v_fmac_f32 v50, v28, v68
    v_mfma_f32_16x16x32_bf16 v[36:39], a[152:155], a[216:219], 0
    v_fmac_f32 v50, v29, v69
    v_fmac_f32 v50, v30, v70
L_step63:
    s_waitcnt vmcnt(8) lgkmcnt(0)
    v_mfma_f32_16x16x32_bf16 v[140:143], v[100:103], v[124:127], v[140:143]
    s_barrier
    ds_read_b64_tr_b16 v[92:93], v4 offset:32768
    ds_read_b128 v[108:111], v1 offset:16512
    s_add_u32 m0, s55, 16384
    s_mov_b32 s56, 516096
    v_mfma_f32_16x16x32_bf16 v[148:151], v[100:103], v[128:131], v[148:151]
    buffer_load_dwordx4 v5, s[28:31], s56 offen  lds
    v_fmac_f32 v50, v31, v71
    v_mfma_f32_16x16x32_bf16 v[152:155], v[104:107], v[128:131], v[152:155]
    ds_read_b64_tr_b16 v[94:95], v4 offset:33792
    v_fmac_f32 v50, v32, v72
    v_mfma_f32_16x16x32_bf16 v[144:147], v[104:107], v[124:127], v[144:147]
    ds_read_b128 v[112:115], v1 offset:17536
    v_fmac_f32 v50, v33, v73
    v_mfma_f32_16x16x32_bf16 v[28:31], v[184:187], a[220:223], 0
    ds_read_b64_tr_b16 v[96:97], v2 offset:32768
    v_fmac_f32 v50, v34, v74
    v_mfma_f32_16x16x32_bf16 v[160:163], v[104:107], v[132:135], v[160:163]
    buffer_load_dwordx4 v5, s[28:31], s56 offen offset:1024  lds
    s_add_u32 m0, s54, 28896
    v_add_u32_dpp v7, v211, v6 quad_perm:[2,2,2,2] row_mask:0xf bank_mask:0xf
    v_fmac_f32 v50, v35, v75
    v_mfma_f32_16x16x32_bf16 v[32:35], a[220:223], a[220:223], 0
    ds_read_b128 v[116:119], v1 offset:18560
    v_fmac_f32 v50, v36, v76
    v_mfma_f32_16x16x32_bf16 v[156:159], v[100:103], v[132:135], v[156:159]
    ds_read_b64_tr_b16 v[98:99], v2 offset:33792
    v_fmac_f32 v50, v37, v77
    v_fmac_f32 v50, v38, v78
    v_fmac_f32 v50, v39, v79
    v_mfma_f32_16x16x32_bf16 v[36:39], a[28:31], a[220:223], 0
    buffer_load_dwordx4 v7, s[24:27], 0 offen  lds
    v_fmac_f32 v51, v29, v60
    v_mfma_f32_16x16x32_bf16 v[164:167], v[100:103], v[136:139], v[164:167]
    ds_read_b128 v[120:123], v1 offset:19584
    v_fmac_f32 v51, v32, v80
    v_mfma_f32_16x16x32_bf16 v[28:31], a[92:95], a[220:223], 0
    v_fmac_f32 v51, v33, v81
    v_fmac_f32 v51, v34, v82
    v_mfma_f32_16x16x32_bf16 v[168:171], v[104:107], v[136:139], v[168:171]
    v_fmac_f32 v51, v35, v83
    v_fmac_f32 v51, v36, v68
    v_mfma_f32_16x16x32_bf16 v[32:35], a[156:159], a[220:223], 0
    v_fmac_f32 v51, v37, v69
    v_fmac_f32 v51, v38, v70
L_step64:
    s_waitcnt vmcnt(7) lgkmcnt(0)
    v_mfma_f32_16x16x32_bf16 v[140:143], v[92:95], v[108:111], v[140:143]
    s_barrier
    ds_read_b64_tr_b16 v[100:101], v4 offset:0
    ds_read_b128 v[124:127], v1 offset:20640
    s_add_u32 m0, s55, 24576
    s_mov_b32 s56, 524288
    v_mfma_f32_16x16x32_bf16 v[148:151], v[92:95], v[112:115], v[148:151]
    buffer_load_dwordx4 v5, s[28:31], s56 offen  lds
    v_fmac_f32 v51, v39, v71
    v_mfma_f32_16x16x32_bf16 v[152:155], v[96:99], v[112:115], v[152:155]
    ds_read_b64_tr_b16 v[102:103], v4 offset:1024
    v_fmac_f32 v51, v28, v72
    v_mfma_f32_16x16x32_bf16 v[144:147], v[96:99], v[108:111], v[144:147]
    ds_read_b128 v[128:131], v1 offset:21664
    v_fmac_f32 v51, v29, v73
    v_mfma_f32_16x16x32_bf16 v[36:39], v[172:175], a[224:227], 0
    ds_read_b128 v[84:87], v12 offset:14336
    ds_read_b64_tr_b16 v[104:105], v2 offset:0
    v_mfma_f32_16x16x32_bf16 v[160:163], v[96:99], v[116:119], v[160:163]
    buffer_load_dwordx4 v5, s[28:31], s56 offen offset:1024  lds
    s_add_u32 m0, s54, 33024
    v_add_u32_dpp v7, v208, v6 quad_perm:[3,3,3,3] row_mask:0xf bank_mask:0xf
    v_fmac_f32 v51, v30, v74
    v_fmac_f32 v51, v31, v75
    v_mfma_f32_16x16x32_bf16 v[28:31], a[224:227], a[224:227], 0
    ds_read_b128 v[132:135], v1 offset:22688
    v_fmac_f32 v51, v32, v76
    v_mfma_f32_16x16x32_bf16 v[156:159], v[92:95], v[116:119], v[156:159]
    ds_read_b64_tr_b16 v[106:107], v2 offset:1024
    v_fmac_f32 v51, v33, v77
    v_fmac_f32 v51, v34, v78
    v_fmac_f32 v51, v35, v79
    v_mfma_f32_16x16x32_bf16 v[32:35], a[32:35], a[224:227], 0
    buffer_load_dwordx4 v7, s[24:27], 0 offen  lds
    v_fmac_f32 v52, v38, v60
    v_mfma_f32_16x16x32_bf16 v[164:167], v[92:95], v[120:123], v[164:167]
    ds_read_b128 v[136:139], v1 offset:23712
    v_fmac_f32 v52, v28, v80
    v_mfma_f32_16x16x32_bf16 v[36:39], a[96:99], a[224:227], 0
    v_fmac_f32 v52, v29, v81
    v_fmac_f32 v52, v30, v82
    v_mfma_f32_16x16x32_bf16 v[168:171], v[96:99], v[120:123], v[168:171]
    v_fmac_f32 v52, v31, v83
    v_fmac_f32 v52, v32, v68
    v_mfma_f32_16x16x32_bf16 v[28:31], a[160:163], a[224:227], 0
    v_fmac_f32 v52, v33, v69
    v_fmac_f32 v52, v34, v70
L_step65:
    s_waitcnt vmcnt(7) lgkmcnt(0)
    v_mfma_f32_16x16x32_bf16 v[140:143], v[100:103], v[124:127], v[140:143]
    s_barrier
    ds_read_b64_tr_b16 v[92:93], v4 offset:8192
    ds_read_b128 v[108:111], v1 offset:24768
    s_add_u32 m0, s55, 32768
    s_mov_b32 s56, 532480
    v_mfma_f32_16x16x32_bf16 v[148:151], v[100:103], v[128:131], v[148:151]
    buffer_load_dwordx4 v5, s[28:31], s56 offen  lds
    v_fmac_f32 v52, v35, v71
    v_mfma_f32_16x16x32_bf16 v[152:155], v[104:107], v[128:131], v[152:155]
    ds_read_b64_tr_b16 v[94:95], v4 offset:9216
    v_fmac_f32 v52, v36, v72
    v_mfma_f32_16x16x32_bf16 v[144:147], v[104:107], v[124:127], v[144:147]
    ds_read_b128 v[112:115], v1 offset:25792
    v_fmac_f32 v52, v37, v73
    v_mfma_f32_16x16x32_bf16 v[32:35], v[176:179], a[228:231], 0
    ds_read_b64_tr_b16 v[96:97], v2 offset:8192
    v_fmac_f32 v52, v38, v74
    v_mfma_f32_16x16x32_bf16 v[160:163], v[104:107], v[132:135], v[160:163]
    buffer_load_dwordx4 v5, s[28:31], s56 offen offset:1024  lds
    s_add_u32 m0, s54, 37152
    v_add_u32_dpp v7, v209, v6 quad_perm:[3,3,3,3] row_mask:0xf bank_mask:0xf
    v_fmac_f32 v52, v39, v75
    v_mfma_f32_16x16x32_bf16 v[36:39], a[228:231], a[228:231], 0
    ds_read_b128 v[116:119], v1 offset:26816
    v_fmac_f32 v52, v28, v76
    v_mfma_f32_16x16x32_bf16 v[156:159], v[100:103], v[132:135], v[156:159]
    ds_read_b64_tr_b16 v[98:99], v2 offset:9216
    v_fmac_f32 v52, v29, v77
    v_fmac_f32 v52, v30, v78
    v_fmac_f32 v52, v31, v79
    v_mfma_f32_16x16x32_bf16 v[28:31], a[36:39], a[228:231], 0
    buffer_load_dwordx4 v7, s[24:27], 0 offen  lds
    v_fmac_f32 v53, v34, v60
    v_mfma_f32_16x16x32_bf16 v[164:167], v[100:103], v[136:139], v[164:167]
    ds_read_b128 v[120:123], v1 offset:27840
    v_fmac_f32 v53, v36, v80
    v_mfma_f32_16x16x32_bf16 v[32:35], a[100:103], a[228:231], 0
    v_fmac_f32 v53, v37, v81
    v_fmac_f32 v53, v38, v82
    v_mfma_f32_16x16x32_bf16 v[168:171], v[104:107], v[136:139], v[168:171]
    v_fmac_f32 v53, v39, v83
    v_fmac_f32 v53, v28, v68
    v_mfma_f32_16x16x32_bf16 v[36:39], a[164:167], a[228:231], 0
    v_fmac_f32 v53, v29, v69
    v_fmac_f32 v53, v30, v70
L_step66:
    s_waitcnt vmcnt(7) lgkmcnt(0)
    v_mfma_f32_16x16x32_bf16 v[140:143], v[92:95], v[108:111], v[140:143]
    s_barrier
    ds_read_b64_tr_b16 v[100:101], v4 offset:16384
    ds_read_b128 v[124:127], v1 offset:28896
    s_add_u32 m0, s55, 0
    s_mov_b32 s56, 540672
    v_mfma_f32_16x16x32_bf16 v[148:151], v[92:95], v[112:115], v[148:151]
    buffer_load_dwordx4 v5, s[28:31], s56 offen  lds
    v_fmac_f32 v53, v31, v71
    v_mfma_f32_16x16x32_bf16 v[152:155], v[96:99], v[112:115], v[152:155]
    ds_read_b64_tr_b16 v[102:103], v4 offset:17408
    v_fmac_f32 v53, v32, v72
    v_mfma_f32_16x16x32_bf16 v[144:147], v[96:99], v[108:111], v[144:147]
    ds_read_b128 v[128:131], v1 offset:29920
    v_fmac_f32 v53, v33, v73
    v_mfma_f32_16x16x32_bf16 v[28:31], v[180:183], a[232:235], 0
    ds_read_b64_tr_b16 v[104:105], v2 offset:16384
    v_fmac_f32 v53, v34, v74
    v_mfma_f32_16x16x32_bf16 v[160:163], v[96:99], v[116:119], v[160:163]
    buffer_load_dwordx4 v5, s[28:31], s56 offen offset:1024  lds
    s_add_u32 m0, s54, 41280
    v_add_u32_dpp v7, v210, v6 quad_perm:[3,3,3,3] row_mask:0xf bank_mask:0xf
    v_fmac_f32 v53, v35, v75
    v_mfma_f32_16x16x32_bf16 v[32:35], a[232:235], a[232:235], 0
    ds_read_b128 v[132:135], v1 offset:30944
    v_fmac_f32 v53, v36, v76
    v_mfma_f32_16x16x32_bf16 v[156:159], v[92:95], v[116:119], v[156:159]
    ds_read_b64_tr_b16 v[106:107], v2 offset:17408
    v_fmac_f32 v53, v37, v77
    v_fmac_f32 v53, v38, v78
    v_fmac_f32 v53, v39, v79
    v_mfma_f32_16x16x32_bf16 v[36:39], a[40:43], a[232:235], 0
    buffer_load_dwordx4 v7, s[24:27], 0 offen  lds
    v_fmac_f32 v54, v30, v60
    v_mfma_f32_16x16x32_bf16 v[164:167], v[92:95], v[120:123], v[164:167]
    ds_read_b128 v[136:139], v1 offset:31968
    v_fmac_f32 v54, v32, v80
    v_mfma_f32_16x16x32_bf16 v[28:31], a[104:107], a[232:235], 0
    v_fmac_f32 v54, v33, v81
    v_fmac_f32 v54, v34, v82
    v_mfma_f32_16x16x32_bf16 v[168:171], v[96:99], v[120:123], v[168:171]
    v_fmac_f32 v54, v35, v83
    v_fmac_f32 v54, v36, v68
    v_mfma_f32_16x16x32_bf16 v[32:35], a[168:171], a[232:235], 0
    v_fmac_f32 v54, v37, v69
    v_fmac_f32 v54, v38, v70
L_step67:
    s_waitcnt vmcnt(7) lgkmcnt(0)
    v_mfma_f32_16x16x32_bf16 v[140:143], v[100:103], v[124:127], v[140:143]
    s_barrier
    ds_read_b64_tr_b16 v[92:93], v4 offset:24576
    ds_read_b128 v[108:111], v1 offset:33024
    s_add_u32 m0, s55, 8192
    s_mov_b32 s56, 548864
    v_mfma_f32_16x16x32_bf16 v[148:151], v[100:103], v[128:131], v[148:151]
    buffer_load_dwordx4 v5, s[28:31], s56 offen  lds
    v_fmac_f32 v54, v39, v71
    v_mfma_f32_16x16x32_bf16 v[152:155], v[104:107], v[128:131], v[152:155]
    ds_read_b64_tr_b16 v[94:95], v4 offset:25600
    v_fmac_f32 v54, v28, v72
    v_mfma_f32_16x16x32_bf16 v[144:147], v[104:107], v[124:127], v[144:147]
    ds_read_b128 v[112:115], v1 offset:34048
    v_fmac_f32 v54, v29, v73
    v_mfma_f32_16x16x32_bf16 v[36:39], v[184:187], a[236:239], 0
    ds_read_b64_tr_b16 v[96:97], v2 offset:24576
    v_fmac_f32 v54, v30, v74
    v_mfma_f32_16x16x32_bf16 v[160:163], v[104:107], v[132:135], v[160:163]
    buffer_load_dwordx4 v5, s[28:31], s56 offen offset:1024  lds
    s_add_u32 m0, s54, 45408
    v_add_u32_dpp v7, v211, v6 quad_perm:[3,3,3,3] row_mask:0xf bank_mask:0xf
    v_fmac_f32 v54, v31, v75
    v_mfma_f32_16x16x32_bf16 v[28:31], a[236:239], a[236:239], 0
    ds_read_b128 v[116:119], v1 offset:35072
    v_fmac_f32 v54, v32, v76
    v_mfma_f32_16x16x32_bf16 v[156:159], v[100:103], v[132:135], v[156:159]
    ds_read_b64_tr_b16 v[98:99], v2 offset:25600
    v_fmac_f32 v54, v33, v77
    v_fmac_f32 v54, v34, v78
    v_fmac_f32 v54, v35, v79
    v_mfma_f32_16x16x32_bf16 v[32:35], a[44:47], a[236:239], 0
    buffer_load_dwordx4 v7, s[24:27], 0 offen  lds
    v_fmac_f32 v55, v38, v60
    v_mfma_f32_16x16x32_bf16 v[164:167], v[100:103], v[136:139], v[164:167]
    ds_read_b128 v[120:123], v1 offset:36096
    v_fmac_f32 v55, v28, v80
    v_mfma_f32_16x16x32_bf16 v[36:39], a[108:111], a[236:239], 0
    v_fmac_f32 v55, v29, v81
    v_fmac_f32 v55, v30, v82
    v_mfma_f32_16x16x32_bf16 v[168:171], v[104:107], v[136:139], v[168:171]
    v_fmac_f32 v55, v31, v83
    v_fmac_f32 v55, v32, v68
    v_mfma_f32_16x16x32_bf16 v[28:31], a[172:175], a[236:239], 0
    v_fmac_f32 v55, v33, v69
    v_fmac_f32 v55, v34, v70
L_step68:
    s_waitcnt vmcnt(7) lgkmcnt(0)
    v_mfma_f32_16x16x32_bf16 v[140:143], v[92:95], v[108:111], v[140:143]
    s_barrier
    ds_read_b64_tr_b16 v[100:101], v4 offset:32768
    ds_read_b128 v[124:127], v1 offset:37152
    s_add_u32 m0, s55, 16384
    s_mov_b32 s56, 557056
    v_mfma_f32_16x16x32_bf16 v[148:151], v[92:95], v[112:115], v[148:151]
    buffer_load_dwordx4 v5, s[28:31], s56 offen  lds
    v_fmac_f32 v55, v35, v71
    v_mfma_f32_16x16x32_bf16 v[152:155], v[96:99], v[112:115], v[152:155]
    ds_read_b64_tr_b16 v[102:103], v4 offset:33792
    v_fmac_f32 v55, v36, v72
    v_mfma_f32_16x16x32_bf16 v[144:147], v[96:99], v[108:111], v[144:147]
    ds_read_b128 v[128:131], v1 offset:38176
    v_fmac_f32 v55, v37, v73
    v_mfma_f32_16x16x32_bf16 v[32:35], v[172:175], a[240:243], 0
    ds_read_b64_tr_b16 v[104:105], v2 offset:32768
    v_fmac_f32 v55, v38, v74
    v_mfma_f32_16x16x32_bf16 v[160:163], v[96:99], v[116:119], v[160:163]
    buffer_load_dwordx4 v5, s[28:31], s56 offen offset:1024  lds
    s_add_u32 m0, s54, 49536
    v_add_u32_dpp v7, v20, v6 quad_perm:[0,0,0,0] row_mask:0xf bank_mask:0xf
    v_fmac_f32 v55, v39, v75
    v_mfma_f32_16x16x32_bf16 v[36:39], a[240:243], a[240:243], 0
    ds_read_b128 v[132:135], v1 offset:39200
    v_fmac_f32 v55, v28, v76
    v_mfma_f32_16x16x32_bf16 v[156:159], v[92:95], v[116:119], v[156:159]
    ds_read_b64_tr_b16 v[106:107], v2 offset:33792
    v_fmac_f32 v55, v29, v77
    v_fmac_f32 v55, v30, v78
    v_fmac_f32 v55, v31, v79
    v_mfma_f32_16x16x32_bf16 v[28:31], a[48:51], a[240:243], 0
    buffer_load_dwordx4 v7, s[24:27], 0 offen  lds
    v_fmac_f32 v56, v35, v60
    v_mfma_f32_16x16x32_bf16 v[164:167], v[92:95], v[120:123], v[164:167]
    ds_read_b128 v[136:139], v1 offset:40224
    v_fmac_f32 v56, v36, v80
    v_mfma_f32_16x16x32_bf16 v[32:35], a[112:115], a[240:243], 0
    v_fmac_f32 v56, v37, v81
    v_fmac_f32 v56, v38, v82
    v_mfma_f32_16x16x32_bf16 v[168:171], v[96:99], v[120:123], v[168:171]
    v_fmac_f32 v56, v39, v83
    v_fmac_f32 v56, v28, v68
    v_mfma_f32_16x16x32_bf16 v[36:39], a[176:179], a[240:243], 0
    v_fmac_f32 v56, v29, v69
    v_fmac_f32 v56, v30, v70
L_step69:
    s_waitcnt vmcnt(7) lgkmcnt(0)
    v_mfma_f32_16x16x32_bf16 v[140:143], v[100:103], v[124:127], v[140:143]
    s_barrier
    ds_read_b64_tr_b16 v[92:93], v4 offset:0
    ds_read_b128 v[108:111], v1 offset:41280
    s_add_u32 m0, s55, 24576
    s_mov_b32 s56, 565248
    v_mfma_f32_16x16x32_bf16 v[148:151], v[100:103], v[128:131], v[148:151]
    buffer_load_dwordx4 v5, s[28:31], s56 offen  lds
    v_fmac_f32 v56, v31, v71
    v_mfma_f32_16x16x32_bf16 v[152:155], v[104:107], v[128:131], v[152:155]
    ds_read_b64_tr_b16 v[94:95], v4 offset:1024
    v_fmac_f32 v56, v32, v72
    v_mfma_f32_16x16x32_bf16 v[144:147], v[104:107], v[124:127], v[144:147]
    ds_read_b128 v[112:115], v1 offset:42304
    v_fmac_f32 v56, v33, v73
    v_mfma_f32_16x16x32_bf16 v[28:31], v[176:179], a[244:247], 0
    ds_read_b64_tr_b16 v[96:97], v2 offset:0
    v_fmac_f32 v56, v34, v74
    v_mfma_f32_16x16x32_bf16 v[160:163], v[104:107], v[132:135], v[160:163]
    buffer_load_dwordx4 v5, s[28:31], s56 offen offset:1024  lds
    s_add_u32 m0, s54, 53664
    v_add_u32_dpp v7, v21, v6 quad_perm:[0,0,0,0] row_mask:0xf bank_mask:0xf
    v_fmac_f32 v56, v35, v75
    v_mfma_f32_16x16x32_bf16 v[32:35], a[244:247], a[244:247], 0
    ds_read_b128 v[116:119], v1 offset:43328
    v_fmac_f32 v56, v36, v76
    v_mfma_f32_16x16x32_bf16 v[156:159], v[100:103], v[132:135], v[156:159]
    ds_read_b64_tr_b16 v[98:99], v2 offset:1024
    v_fmac_f32 v56, v37, v77
    v_fmac_f32 v56, v38, v78
    v_fmac_f32 v56, v39, v79
    v_mfma_f32_16x16x32_bf16 v[36:39], a[52:55], a[244:247], 0
    buffer_load_dwordx4 v7, s[24:27], 0 offen  lds
    v_fmac_f32 v57, v31, v60
    v_mfma_f32_16x16x32_bf16 v[164:167], v[100:103], v[136:139], v[164:167]
    ds_read_b128 v[120:123], v1 offset:44352
    v_fmac_f32 v57, v32, v80
    v_mfma_f32_16x16x32_bf16 v[28:31], a[116:119], a[244:247], 0
    v_fmac_f32 v57, v33, v81
    v_fmac_f32 v57, v34, v82
    v_mfma_f32_16x16x32_bf16 v[168:171], v[104:107], v[136:139], v[168:171]
    v_fmac_f32 v57, v35, v83
    v_fmac_f32 v57, v36, v68
    v_mfma_f32_16x16x32_bf16 v[32:35], a[180:183], a[244:247], 0
    v_fmac_f32 v57, v37, v69
    v_fmac_f32 v57, v38, v70
L_step70:
    s_waitcnt vmcnt(7) lgkmcnt(0)
    v_mfma_f32_16x16x32_bf16 v[140:143], v[92:95], v[108:111], v[140:143]
    s_barrier
    ds_read_b64_tr_b16 v[100:101], v4 offset:8192
    ds_read_b128 v[124:127], v1 offset:45408
    s_add_u32 m0, s55, 32768
    s_mov_b32 s56, 573440
    v_mfma_f32_16x16x32_bf16 v[148:151], v[92:95], v[112:115], v[148:151]
    buffer_load_dwordx4 v5, s[28:31], s56 offen  lds
    ds_read_b64_tr_b16 v[102:103], v4 offset:9216
    v_mfma_f32_16x16x32_bf16 v[152:155], v[96:99], v[112:115], v[152:155]
    ds_read_b128 v[128:131], v1 offset:46432
    v_fmac_f32 v57, v39, v71
    v_mfma_f32_16x16x32_bf16 v[144:147], v[96:99], v[108:111], v[144:147]
    ds_read_b64_tr_b16 v[104:105], v2 offset:8192
    v_fmac_f32 v57, v28, v72
    v_mfma_f32_16x16x32_bf16 v[36:39], v[180:183], a[248:251], 0
    ds_read_b128 v[132:135], v1 offset:47456
    v_fmac_f32 v57, v29, v73
    v_mfma_f32_16x16x32_bf16 v[160:163], v[96:99], v[116:119], v[160:163]
    buffer_load_dwordx4 v5, s[28:31], s56 offen offset:1024  lds
    s_add_u32 m0, s54, 57792
    v_add_u32_dpp v7, v22, v6 quad_perm:[0,0,0,0] row_mask:0xf bank_mask:0xf
    v_fmac_f32 v57, v30, v74
    v_fmac_f32 v57, v31, v75
    v_mfma_f32_16x16x32_bf16 v[28:31], a[248:251], a[248:251], 0
    ds_read_b64_tr_b16 v[106:107], v2 offset:9216
    v_fmac_f32 v57, v32, v76
    v_mfma_f32_16x16x32_bf16 v[156:159], v[92:95], v[116:119], v[156:159]
    ds_read_b128 v[136:139], v1 offset:48480
    v_fmac_f32 v57, v33, v77
    v_fmac_f32 v57, v34, v78
    v_fmac_f32 v57, v35, v79
    v_mfma_f32_16x16x32_bf16 v[32:35], a[56:59], a[248:251], 0
    buffer_load_dwordx4 v7, s[24:27], 0 offen  lds
    v_add_u32 v190, L_step78-L_pc, v189
    v_mfma_f32_16x16x32_bf16 v[164:167], v[92:95], v[120:123], v[164:167]
    v_fmac_f32 v58, v39, v60
    v_fmac_f32 v58, v28, v80
    v_mfma_f32_16x16x32_bf16 v[36:39], a[120:123], a[248:251], 0
    global_load_dword v190, v190, s[62:63]
    v_fmac_f32 v58, v29, v81
    v_mfma_f32_16x16x32_bf16 v[168:171], v[96:99], v[120:123], v[168:171]
    v_fmac_f32 v58, v30, v82
    v_fmac_f32 v58, v31, v83
    v_mfma_f32_16x16x32_bf16 v[28:31], a[184:187], a[248:251], 0
    v_fmac_f32 v58, v32, v68
    v_fmac_f32 v58, v33, v69
L_step71:
    s_waitcnt vmcnt(8) lgkmcnt(0)
    v_mfma_f32_16x16x32_bf16 v[140:143], v[100:103], v[124:127], v[140:143]
    s_barrier
    ds_read_b64_tr_b16 v[92:93], v4 offset:16384
    ds_read_b128 v[108:111], v0 offset:0
    s_add_u32 m0, s55, 0
    s_mov_b32 s56, 581632
    s_mov_b32 vcc_lo, 0xfff0fff0
    s_mov_b32 vcc_hi, 0xfff0fff0
    v_add_u32 v9, 82560, v8
    v_subrev_u32 v17, 16512, v8
    v_cndmask_b32 v9, v9, v17, vcc
    v_xad_u32 v10, v11, 0, v9
    v_mfma_f32_16x16x32_bf16 v[148:151], v[100:103], v[128:131], v[148:151]
    ds_read_b128 v[192:195], v10 offset:0
    ds_read_b128 v[196:199], v10 offset:64
    v_mfma_f32_16x16x32_bf16 v[152:155], v[104:107], v[128:131], v[152:155]
    ds_read_b128 v[200:203], v10 offset:128
    buffer_load_dwordx4 v5, s[28:31], s56 offen  lds
    v_mfma_f32_16x16x32_bf16 v[144:147], v[104:107], v[124:127], v[144:147]
    ds_read_b128 v[204:207], v10 offset:192
    ds_read_b64_tr_b16 v[94:95], v4 offset:17408
    v_fmac_f32 v58, v34, v70
    v_fmac_f32 v58, v35, v71
    v_mfma_f32_16x16x32_bf16 v[32:35], v[184:187], a[252:255], 0
    ds_read_b128 v[112:115], v0 offset:1024
    ds_read_b64_tr_b16 v[96:97], v2 offset:16384
    v_mfma_f32_16x16x32_bf16 v[160:163], v[104:107], v[132:135], v[160:163]
    ds_read_b128 v[116:119], v0 offset:2048
    v_fmac_f32 v58, v36, v72
    v_fmac_f32 v58, v37, v73
    v_fmac_f32 v58, v38, v74
    v_fmac_f32 v58, v39, v75
    v_mfma_f32_16x16x32_bf16 v[36:39], a[252:255], a[252:255], 0
    buffer_load_dwordx4 v5, s[28:31], s56 offen offset:1024  lds
    s_add_u32 m0, s54, 61920
    v_add_u32_dpp v7, v23, v6 quad_perm:[0,0,0,0] row_mask:0xf bank_mask:0xf
    v_mfma_f32_16x16x32_bf16 v[156:159], v[100:103], v[132:135], v[156:159]
    ds_read_b64_tr_b16 v[98:99], v2 offset:17408
    v_fmac_f32 v58, v28, v76
    v_fmac_f32 v58, v29, v77
    v_fmac_f32 v58, v30, v78
    v_fmac_f32 v58, v31, v79
    v_mfma_f32_16x16x32_bf16 v[28:31], a[60:63], a[252:255], 0
    ds_read_b128 v[120:123], v0 offset:3072
    v_fmac_f32 v59, v35, v60
    v_mfma_f32_16x16x32_bf16 v[164:167], v[100:103], v[136:139], v[164:167]
    buffer_load_dwordx4 v7, s[24:27], 0 offen  lds
    v_fmac_f32 v59, v36, v80
    v_mfma_f32_16x16x32_bf16 v[32:35], a[124:127], a[252:255], 0
    v_fmac_f32 v59, v37, v81
    v_fmac_f32 v59, v38, v82
    v_mfma_f32_16x16x32_bf16 v[168:171], v[104:107], v[136:139], v[168:171]
    v_fmac_f32 v59, v39, v83
    v_fmac_f32 v59, v28, v68
    v_mfma_f32_16x16x32_bf16 v[36:39], a[188:191], a[252:255], 0
    ds_read_b128 v[80:83], v12 offset:13312
    v_fmac_f32 v59, v29, v69
L_step72:
    s_waitcnt vmcnt(8) lgkmcnt(1)
    v_mfma_f32_16x16x32_bf16 v[140:143], v[92:95], v[108:111], v[140:143]
    s_barrier
    ds_read_b64_tr_b16 v[100:101], v4 offset:24576
    ds_read_b128 v[124:127], v0 offset:4128
    s_add_u32 m0, s55, 8192
    s_mov_b32 s56, 589824
    v_xad_u32 v10, v11, 48, v9
    v_mfma_f32_16x16x32_bf16 v[148:151], v[92:95], v[112:115], v[148:151]
    ds_read_b128 v[208:211], v10 offset:256
    ds_read_b128 v[212:215], v10 offset:320
    v_mfma_f32_16x16x32_bf16 v[152:155], v[96:99], v[112:115], v[152:155]
    ds_read_b128 v[216:219], v10 offset:384
    buffer_load_dwordx4 v5, s[28:31], s56 offen  lds
    v_mfma_f32_16x16x32_bf16 v[144:147], v[96:99], v[108:111], v[144:147]
    ds_read_b128 v[220:223], v10 offset:448
    ds_read_b64_tr_b16 v[102:103], v4 offset:25600
    v_fmac_f32 v59, v30, v70
    v_fmac_f32 v59, v31, v71
    v_mfma_f32_16x16x32_bf16 v[28:31], v[172:175], v[192:195], 0
    ds_read_b128 v[68:71], v12 offset:10240
    ds_read_b128 v[128:131], v0 offset:5152
    v_mfma_f32_16x16x32_bf16 v[160:163], v[96:99], v[116:119], v[160:163]
    v_fmac_f32 v59, v32, v72
    v_fmac_f32 v59, v33, v73
    v_fmac_f32 v59, v34, v74
    v_fmac_f32 v59, v35, v75
    v_mfma_f32_16x16x32_bf16 v[32:35], v[192:195], v[192:195], 0
    ds_read_b128 v[72:75], v12 offset:11264
    buffer_load_dwordx4 v5, s[28:31], s56 offen offset:1024  lds
    s_add_u32 m0, s54, 66048
    v_add_u32_dpp v7, v20, v6 quad_perm:[1,1,1,1] row_mask:0xf bank_mask:0xf
    v_mfma_f32_16x16x32_bf16 v[156:159], v[92:95], v[116:119], v[156:159]
    ds_read_b64_tr_b16 v[104:105], v2 offset:24576
    ds_read_b128 v[132:135], v0 offset:6176
    v_fmac_f32 v59, v36, v76
    v_fmac_f32 v59, v37, v77
    v_fmac_f32 v59, v38, v78
    v_fmac_f32 v59, v39, v79
    v_mfma_f32_16x16x32_bf16 v[36:39], a[0:3], v[192:195], 0
    ds_read_b128 v[76:79], v12 offset:12288
    ds_read_b64_tr_b16 v[106:107], v2 offset:25600
    v_mfma_f32_16x16x32_bf16 v[164:167], v[92:95], v[120:123], v[164:167]
    buffer_load_dwordx4 v7, s[24:27], 0 offen  lds
    v_fmac_f32 v44, v28, v61
    v_mfma_f32_16x16x32_bf16 v[28:31], a[64:67], v[192:195], 0
    ds_read_b128 v[136:139], v0 offset:7200
    v_fmac_f32 v44, v32, v84
    v_mfma_f32_16x16x32_bf16 v[168:171], v[96:99], v[120:123], v[168:171]
    v_fmac_f32 v44, v33, v85
    v_fmac_f32 v44, v34, v86
    v_fmac_f32 v44, v35, v87
    v_mfma_f32_16x16x32_bf16 v[32:35], a[128:131], v[192:195], 0
    s_waitcnt lgkmcnt(7)
    v_fmac_f32 v44, v36, v68
    v_fmac_f32 v44, v37, v69
    v_fmac_f32 v44, v38, v70
    v_fmac_f32 v44, v39, v71
    v_mfma_f32_16x16x32_bf16 v[36:39], a[192:195], v[192:195], 0
    s_waitcnt lgkmcnt(5)
    v_fmac_f32 v44, v28, v72
L_step73:
    s_waitcnt vmcnt(8) lgkmcnt(0)
    v_mfma_f32_16x16x32_bf16 v[140:143], v[100:103], v[124:127], v[140:143]
    s_barrier
    ds_read_b64_tr_b16 v[92:93], v4 offset:32768
    ds_read_b128 v[108:111], v0 offset:8256
    s_add_u32 m0, s55, 16384
    s_mov_b32 s56, 598016
    v_xad_u32 v10, v11, 32, v9
    v_mfma_f32_16x16x32_bf16 v[148:151], v[100:103], v[128:131], v[148:151]
    ds_read_b128 v[224:227], v10 offset:512
    ds_read_b128 v[228:231], v10 offset:576
    v_mfma_f32_16x16x32_bf16 v[152:155], v[104:107], v[128:131], v[152:155]
    ds_read_b128 v[232:235], v10 offset:640
    buffer_load_dwordx4 v5, s[28:31], s56 offen  lds
    v_mfma_f32_16x16x32_bf16 v[144:147], v[104:107], v[124:127], v[144:147]
    ds_read_b128 v[236:239], v10 offset:704
    ds_read_b64_tr_b16 v[94:95], v4 offset:33792
    v_fmac_f32 v44, v29, v73
    v_fmac_f32 v44, v30, v74
    v_fmac_f32 v44, v31, v75
    v_mfma_f32_16x16x32_bf16 v[28:31], v[176:179], v[196:199], 0
    ds_read_b128 v[112:115], v0 offset:9280
    v_fmac_f32 v44, v32, v76
    v_mfma_f32_16x16x32_bf16 v[160:163], v[104:107], v[132:135], v[160:163]
    ds_read_b64_tr_b16 v[96:97], v2 offset:32768
    v_fmac_f32 v44, v33, v77
    v_fmac_f32 v44, v34, v78
    v_fmac_f32 v44, v35, v79
    v_mfma_f32_16x16x32_bf16 v[32:35], v[196:199], v[196:199], 0
    buffer_load_dwordx4 v5, s[28:31], s56 offen offset:1024  lds
    s_add_u32 m0, s54, 70176
    v_add_u32_dpp v7, v21, v6 quad_perm:[1,1,1,1] row_mask:0xf bank_mask:0xf
    v_mfma_f32_16x16x32_bf16 v[156:159], v[100:103], v[132:135], v[156:159]
    ds_read_b128 v[116:119], v0 offset:10304
    v_fmac_f32 v44, v36, v80
    v_fmac_f32 v44, v37, v81
    v_fmac_f32 v44, v38, v82
    v_fmac_f32 v44, v39, v83
    v_mfma_f32_16x16x32_bf16 v[36:39], a[4:7], v[196:199], 0
    ds_read_b64_tr_b16 v[98:99], v2 offset:33792
    v_fmac_f32 v45, v28, v61
    v_mfma_f32_16x16x32_bf16 v[164:167], v[100:103], v[136:139], v[164:167]
    buffer_load_dwordx4 v7, s[24:27], 0 offen  lds
    v_fmac_f32 v45, v32, v84
    v_mfma_f32_16x16x32_bf16 v[28:31], a[68:71], v[196:199], 0
    ds_read_b128 v[120:123], v0 offset:11328
    v_fmac_f32 v45, v33, v85
    v_mfma_f32_16x16x32_bf16 v[168:171], v[104:107], v[136:139], v[168:171]
    v_fmac_f32 v45, v34, v86
    v_fmac_f32 v45, v35, v87
    v_mfma_f32_16x16x32_bf16 v[32:35], a[132:135], v[196:199], 0
    v_fmac_f32 v45, v36, v68
    v_fmac_f32 v45, v37, v69
    v_fmac_f32 v45, v38, v70
    v_fmac_f32 v45, v39, v71
    v_mfma_f32_16x16x32_bf16 v[36:39], a[196:199], v[196:199], 0
    v_fmac_f32 v45, v28, v72
    v_fmac_f32 v45, v29, v73
L_step74:
    s_waitcnt vmcnt(7) lgkmcnt(0)
    v_mfma_f32_16x16x32_bf16 v[140:143], v[92:95], v[108:111], v[140:143]
    s_barrier
    ds_read_b64_tr_b16 v[100:101], v4 offset:0
    ds_read_b128 v[124:127], v0 offset:12384
    s_add_u32 m0, s55, 24576
    s_mov_b32 s56, 606208
    v_xad_u32 v10, v11, 16, v9
    v_mfma_f32_16x16x32_bf16 v[148:151], v[92:95], v[112:115], v[148:151]
    ds_read_b128 v[240:243], v10 offset:768
    ds_read_b128 v[244:247], v10 offset:832
    v_mfma_f32_16x16x32_bf16 v[152:155], v[96:99], v[112:115], v[152:155]
    ds_read_b128 v[248:251], v10 offset:896
    buffer_load_dwordx4 v5, s[28:31], s56 offen  lds
    v_mfma_f32_16x16x32_bf16 v[144:147], v[96:99], v[108:111], v[144:147]
    ds_read_b128 v[252:255], v10 offset:960
    ds_read_b64_tr_b16 v[102:103], v4 offset:1024
    v_fmac_f32 v45, v30, v74
    v_fmac_f32 v45, v31, v75
    v_mfma_f32_16x16x32_bf16 v[28:31], v[180:183], v[200:203], 0
    ds_read_b128 v[128:131], v0 offset:13408
    v_fmac_f32 v45, v32, v76
    v_mfma_f32_16x16x32_bf16 v[160:163], v[96:99], v[116:119], v[160:163]
    ds_read_b64_tr_b16 v[104:105], v2 offset:0
    v_fmac_f32 v45, v33, v77
    v_fmac_f32 v45, v34, v78
    v_fmac_f32 v45, v35, v79
    v_mfma_f32_16x16x32_bf16 v[32:35], v[200:203], v[200:203], 0
    buffer_load_dwordx4 v5, s[28:31], s56 offen offset:1024  lds
    s_add_u32 m0, s54, 74304
    v_add_u32_dpp v7, v22, v6 quad_perm:[1,1,1,1] row_mask:0xf bank_mask:0xf
    v_mfma_f32_16x16x32_bf16 v[156:159], v[92:95], v[116:119], v[156:159]
    ds_read_b128 v[132:135], v0 offset:14432
    v_fmac_f32 v45, v36, v80
    v_fmac_f32 v45, v37, v81
    v_fmac_f32 v45, v38, v82
    v_fmac_f32 v45, v39, v83
    v_mfma_f32_16x16x32_bf16 v[36:39], a[8:11], v[200:203], 0
    ds_read_b64_tr_b16 v[106:107], v2 offset:1024
    v_fmac_f32 v46, v28, v61
    v_mfma_f32_16x16x32_bf16 v[164:167], v[92:95], v[120:123], v[164:167]
    buffer_load_dwordx4 v7, s[24:27], 0 offen  lds
    v_fmac_f32 v46, v32, v84
    v_mfma_f32_16x16x32_bf16 v[28:31], a[72:75], v[200:203], 0
    ds_read_b128 v[136:139], v0 offset:15456
    v_fmac_f32 v46, v33, v85
    v_mfma_f32_16x16x32_bf16 v[168:171], v[96:99], v[120:123], v[168:171]
    v_fmac_f32 v46, v34, v86
    v_fmac_f32 v46, v35, v87
    v_mfma_f32_16x16x32_bf16 v[32:35], a[136:139], v[200:203], 0
    v_fmac_f32 v46, v36, v68
    v_fmac_f32 v46, v37, v69
    v_fmac_f32 v46, v38, v70
    v_fmac_f32 v46, v39, v71
    v_mfma_f32_16x16x32_bf16 v[36:39], a[200:203], v[200:203], 0
    v_fmac_f32 v46, v28, v72
    v_fmac_f32 v46, v29, v73
L_step75:
    s_waitcnt vmcnt(7) lgkmcnt(0)
    v_mfma_f32_16x16x32_bf16 v[140:143], v[100:103], v[124:127], v[140:143]
    s_barrier
    ds_read_b64_tr_b16 v[92:93], v4 offset:8192
    s_add_u32 m0, s55, 32768
    s_mov_b32 s56, 614400
    v_mfma_f32_16x16x32_bf16 v[148:151], v[100:103], v[128:131], v[148:151]
    buffer_load_dwordx4 v5, s[28:31], s56 offen  lds
    v_fmac_f32 v46, v30, v74
    v_mfma_f32_16x16x32_bf16 v[152:155], v[104:107], v[128:131], v[152:155]
    ds_read_b128 v[108:111], v0 offset:16512
    v_fmac_f32 v46, v31, v75
    v_mfma_f32_16x16x32_bf16 v[144:147], v[104:107], v[124:127], v[144:147]
    ds_read_b64_tr_b16 v[94:95], v4 offset:9216
    v_fmac_f32 v46, v32, v76
    v_mfma_f32_16x16x32_bf16 v[28:31], v[184:187], v[204:207], 0
    ds_read_b128 v[112:115], v0 offset:17536
    v_fmac_f32 v46, v33, v77
    v_mfma_f32_16x16x32_bf16 v[160:163], v[104:107], v[132:135], v[160:163]
    buffer_load_dwordx4 v5, s[28:31], s56 offen offset:1024  lds
    s_add_u32 m0, s54, 78432
    v_add_u32_dpp v7, v23, v6 quad_perm:[1,1,1,1] row_mask:0xf bank_mask:0xf
    v_fmac_f32 v46, v34, v78
    v_fmac_f32 v46, v35, v79
    v_mfma_f32_16x16x32_bf16 v[32:35], v[204:207], v[204:207], 0
    ds_read_b64_tr_b16 v[96:97], v2 offset:8192
    v_fmac_f32 v46, v36, v80
    v_mfma_f32_16x16x32_bf16 v[156:159], v[100:103], v[132:135], v[156:159]
    ds_read_b128 v[116:119], v0 offset:18560
    v_fmac_f32 v46, v37, v81
    v_fmac_f32 v46, v38, v82
    v_fmac_f32 v46, v39, v83
    v_mfma_f32_16x16x32_bf16 v[36:39], a[12:15], v[204:207], 0
    buffer_load_dwordx4 v7, s[24:27], 0 offen  lds
    v_fmac_f32 v47, v28, v61
    v_mfma_f32_16x16x32_bf16 v[164:167], v[100:103], v[136:139], v[164:167]
    ds_read_b64_tr_b16 v[98:99], v2 offset:9216
    v_fmac_f32 v47, v32, v84
    v_mfma_f32_16x16x32_bf16 v[28:31], a[76:79], v[204:207], 0
    ds_read_b128 v[120:123], v0 offset:19584
    v_fmac_f32 v47, v33, v85
    v_mfma_f32_16x16x32_bf16 v[168:171], v[104:107], v[136:139], v[168:171]
    v_fmac_f32 v47, v34, v86
    v_fmac_f32 v47, v35, v87
    v_mfma_f32_16x16x32_bf16 v[32:35], a[140:143], v[204:207], 0
    v_fmac_f32 v47, v36, v68
    v_fmac_f32 v47, v37, v69
    v_fmac_f32 v47, v38, v70
    v_fmac_f32 v47, v39, v71
    v_mfma_f32_16x16x32_bf16 v[36:39], a[204:207], v[204:207], 0
    v_fmac_f32 v47, v28, v72
    v_fmac_f32 v47, v29, v73
L_step76:
    s_waitcnt vmcnt(7) lgkmcnt(0)
    v_mfma_f32_16x16x32_bf16 v[140:143], v[92:95], v[108:111], v[140:143]
    s_barrier
    ds_read_b64_tr_b16 v[100:101], v4 offset:16384
    s_add_u32 m0, s55, 0
    s_mov_b32 s56, 622592
    v_mfma_f32_16x16x32_bf16 v[148:151], v[92:95], v[112:115], v[148:151]
    buffer_load_dwordx4 v5, s[28:31], s56 offen  lds
    v_fmac_f32 v47, v30, v74
    v_mfma_f32_16x16x32_bf16 v[152:155], v[96:99], v[112:115], v[152:155]
    ds_read_b128 v[124:127], v0 offset:20640
    v_fmac_f32 v47, v31, v75
    v_mfma_f32_16x16x32_bf16 v[144:147], v[96:99], v[108:111], v[144:147]
    ds_read_b64_tr_b16 v[102:103], v4 offset:17408
    v_fmac_f32 v47, v32, v76
    v_mfma_f32_16x16x32_bf16 v[28:31], v[172:175], v[208:211], 0
    ds_read_b128 v[128:131], v0 offset:21664
    v_fmac_f32 v47, v33, v77
    v_mfma_f32_16x16x32_bf16 v[160:163], v[96:99], v[116:119], v[160:163]
    buffer_load_dwordx4 v5, s[28:31], s56 offen offset:1024  lds
    s_add_u32 m0, s54, 82560
    v_add_u32_dpp v7, v20, v6 quad_perm:[2,2,2,2] row_mask:0xf bank_mask:0xf
    v_fmac_f32 v47, v34, v78
    v_fmac_f32 v47, v35, v79
    v_mfma_f32_16x16x32_bf16 v[32:35], v[208:211], v[208:211], 0
    ds_read_b64_tr_b16 v[104:105], v2 offset:16384
    v_fmac_f32 v47, v36, v80
    v_mfma_f32_16x16x32_bf16 v[156:159], v[92:95], v[116:119], v[156:159]
    ds_read_b128 v[132:135], v0 offset:22688
    v_fmac_f32 v47, v37, v81
    v_fmac_f32 v47, v38, v82
    v_fmac_f32 v47, v39, v83
    v_mfma_f32_16x16x32_bf16 v[36:39], a[16:19], v[208:211], 0
    buffer_load_dwordx4 v7, s[24:27], 0 offen  lds
    v_fmac_f32 v48, v29, v61
    v_mfma_f32_16x16x32_bf16 v[164:167], v[92:95], v[120:123], v[164:167]
    ds_read_b64_tr_b16 v[106:107], v2 offset:17408
    v_fmac_f32 v48, v32, v84
    v_mfma_f32_16x16x32_bf16 v[28:31], a[80:83], v[208:211], 0
    ds_read_b128 v[136:139], v0 offset:23712
    v_fmac_f32 v48, v33, v85
    v_mfma_f32_16x16x32_bf16 v[168:171], v[96:99], v[120:123], v[168:171]
    v_fmac_f32 v48, v34, v86
    v_fmac_f32 v48, v35, v87
    v_mfma_f32_16x16x32_bf16 v[32:35], a[144:147], v[208:211], 0
    v_fmac_f32 v48, v36, v68
    v_fmac_f32 v48, v37, v69
    v_fmac_f32 v48, v38, v70
    v_fmac_f32 v48, v39, v71
    v_mfma_f32_16x16x32_bf16 v[36:39], a[208:211], v[208:211], 0
    v_fmac_f32 v48, v28, v72
    v_fmac_f32 v48, v29, v73
L_step77:
    s_waitcnt vmcnt(7) lgkmcnt(0)
    v_mfma_f32_16x16x32_bf16 v[140:143], v[100:103], v[124:127], v[140:143]
    s_barrier
    ds_read_b64_tr_b16 v[92:93], v4 offset:24576
    s_add_u32 m0, s55, 8192
    s_mov_b32 s56, 630784
    v_mfma_f32_16x16x32_bf16 v[148:151], v[100:103], v[128:131], v[148:151]
    buffer_load_dwordx4 v5, s[28:31], s56 offen  lds
    v_fmac_f32 v48, v30, v74
    v_mfma_f32_16x16x32_bf16 v[152:155], v[104:107], v[128:131], v[152:155]
    ds_read_b128 v[108:111], v0 offset:24768
    v_fmac_f32 v48, v31, v75
    v_mfma_f32_16x16x32_bf16 v[144:147], v[104:107], v[124:127], v[144:147]
    ds_read_b64_tr_b16 v[94:95], v4 offset:25600
    v_fmac_f32 v48, v32, v76
    v_mfma_f32_16x16x32_bf16 v[28:31], v[176:179], v[212:215], 0
    ds_read_b128 v[112:115], v0 offset:25792
    v_fmac_f32 v48, v33, v77
    v_mfma_f32_16x16x32_bf16 v[160:163], v[104:107], v[132:135], v[160:163]
    buffer_load_dwordx4 v5, s[28:31], s56 offen offset:1024  lds
    s_add_u32 m0, s54, 86688
    v_add_u32_dpp v7, v21, v6 quad_perm:[2,2,2,2] row_mask:0xf bank_mask:0xf
    v_fmac_f32 v48, v34, v78
    v_fmac_f32 v48, v35, v79
    v_mfma_f32_16x16x32_bf16 v[32:35], v[212:215], v[212:215], 0
    ds_read_b64_tr_b16 v[96:97], v2 offset:24576
    v_fmac_f32 v48, v36, v80
    v_mfma_f32_16x16x32_bf16 v[156:159], v[100:103], v[132:135], v[156:159]
    ds_read_b128 v[116:119], v0 offset:26816
    v_fmac_f32 v48, v37, v81
    v_fmac_f32 v48, v38, v82
    v_fmac_f32 v48, v39, v83
    v_mfma_f32_16x16x32_bf16 v[36:39], a[20:23], v[212:215], 0
    buffer_load_dwordx4 v7, s[24:27], 0 offen  lds
    v_fmac_f32 v49, v29, v61
    v_mfma_f32_16x16x32_bf16 v[164:167], v[100:103], v[136:139], v[164:167]
    ds_read_b64_tr_b16 v[98:99], v2 offset:25600
    v_fmac_f32 v49, v32, v84
    v_mfma_f32_16x16x32_bf16 v[28:31], a[84:87], v[212:215], 0
    ds_read_b128 v[120:123], v0 offset:27840
    v_fmac_f32 v49, v33, v85
    v_mfma_f32_16x16x32_bf16 v[168:171], v[104:107], v[136:139], v[168:171]
    v_fmac_f32 v49, v34, v86
    v_fmac_f32 v49, v35, v87
    v_mfma_f32_16x16x32_bf16 v[32:35], a[148:151], v[212:215], 0
    v_fmac_f32 v49, v36, v68
    v_fmac_f32 v49, v37, v69
    v_fmac_f32 v49, v38, v70
    v_fmac_f32 v49, v39, v71
    v_mfma_f32_16x16x32_bf16 v[36:39], a[212:215], v[212:215], 0
    v_fmac_f32 v49, v28, v72
    v_fmac_f32 v49, v29, v73
L_step78:
    s_waitcnt vmcnt(7) lgkmcnt(0)
    v_mfma_f32_16x16x32_bf16 v[140:143], v[92:95], v[108:111], v[140:143]
    s_barrier
    ds_read_b64_tr_b16 v[100:101], v4 offset:32768
    s_add_u32 m0, s55, 16384
    s_mov_b32 s56, 638976
    v_mfma_f32_16x16x32_bf16 v[148:151], v[92:95], v[112:115], v[148:151]
    buffer_load_dwordx4 v5, s[28:31], s56 offen  lds
    v_fmac_f32 v49, v30, v74
    v_mfma_f32_16x16x32_bf16 v[152:155], v[96:99], v[112:115], v[152:155]
    ds_read_b128 v[124:127], v0 offset:28896
    v_fmac_f32 v49, v31, v75
    v_mfma_f32_16x16x32_bf16 v[144:147], v[96:99], v[108:111], v[144:147]
    ds_read_b64_tr_b16 v[102:103], v4 offset:33792
    v_fmac_f32 v49, v32, v76
    v_mfma_f32_16x16x32_bf16 v[28:31], v[180:183], v[216:219], 0
    ds_read_b32 v60, v13 offset:1360
    ds_read_b128 v[128:131], v0 offset:29920
    v_mfma_f32_16x16x32_bf16 v[160:163], v[96:99], v[116:119], v[160:163]
    buffer_load_dwordx4 v5, s[28:31], s56 offen offset:1024  lds
    s_add_u32 m0, s54, 90816
    v_add_u32_dpp v7, v22, v6 quad_perm:[2,2,2,2] row_mask:0xf bank_mask:0xf
    v_fmac_f32 v49, v33, v77
    v_fmac_f32 v49, v34, v78
    v_fmac_f32 v49, v35, v79
    v_mfma_f32_16x16x32_bf16 v[32:35], v[216:219], v[216:219], 0
    ds_read_b64_tr_b16 v[104:105], v2 offset:32768
    v_fmac_f32 v49, v36, v80
    v_mfma_f32_16x16x32_bf16 v[156:159], v[92:95], v[116:119], v[156:159]
    ds_read_b128 v[132:135], v0 offset:30944
    v_fmac_f32 v49, v37, v81
    v_fmac_f32 v49, v38, v82
    v_fmac_f32 v49, v39, v83
    v_mfma_f32_16x16x32_bf16 v[36:39], a[24:27], v[216:219], 0
    buffer_load_dwordx4 v7, s[24:27], 0 offen  lds
    v_fmac_f32 v50, v29, v61
    v_mfma_f32_16x16x32_bf16 v[164:167], v[92:95], v[120:123], v[164:167]
    ds_read_b64_tr_b16 v[106:107], v2 offset:33792
    v_fmac_f32 v50, v32, v84
    v_mfma_f32_16x16x32_bf16 v[28:31], a[88:91], v[216:219], 0
    ds_read_b128 v[136:139], v0 offset:31968
    v_fmac_f32 v50, v33, v85
    v_mfma_f32_16x16x32_bf16 v[168:171], v[96:99], v[120:123], v[168:171]
    v_fmac_f32 v50, v34, v86
    v_fmac_f32 v50, v35, v87
    v_mfma_f32_16x16x32_bf16 v[32:35], a[152:155], v[216:219], 0
    v_fmac_f32 v50, v36, v68
    v_fmac_f32 v50, v37, v69
    v_fmac_f32 v50, v38, v70
    v_fmac_f32 v50, v39, v71
    v_mfma_f32_16x16x32_bf16 v[36:39], a[216:219], v[216:219], 0
    v_fmac_f32 v50, v28, v72
    v_fmac_f32 v50, v29, v73
L_step79:
    s_waitcnt vmcnt(7) lgkmcnt(0)
    v_mfma_f32_16x16x32_bf16 v[140:143], v[100:103], v[124:127], v[140:143]
    s_barrier
    ds_read_b64_tr_b16 v[92:93], v4 offset:0
    s_add_u32 m0, s55, 24576
    s_mov_b32 s56, 647168
    v_mfma_f32_16x16x32_bf16 v[148:151], v[100:103], v[128:131], v[148:151]
    buffer_load_dwordx4 v5, s[28:31], s56 offen  lds
    v_fmac_f32 v50, v30, v74
    v_mfma_f32_16x16x32_bf16 v[152:155], v[104:107], v[128:131], v[152:155]
    ds_read_b128 v[108:111], v0 offset:33024
    v_fmac_f32 v50, v31, v75
    v_mfma_f32_16x16x32_bf16 v[144:147], v[104:107], v[124:127], v[144:147]
    ds_read_b64_tr_b16 v[94:95], v4 offset:1024
    v_fmac_f32 v50, v32, v76
    v_mfma_f32_16x16x32_bf16 v[28:31], v[184:187], v[220:223], 0
    ds_read_b128 v[112:115], v0 offset:34048
    v_fmac_f32 v50, v33, v77
    v_mfma_f32_16x16x32_bf16 v[160:163], v[104:107], v[132:135], v[160:163]
    buffer_load_dwordx4 v5, s[28:31], s56 offen offset:1024  lds
    s_add_u32 m0, s54, 94944
    v_add_u32_dpp v7, v23, v6 quad_perm:[2,2,2,2] row_mask:0xf bank_mask:0xf
    v_fmac_f32 v50, v34, v78
    v_fmac_f32 v50, v35, v79
    v_mfma_f32_16x16x32_bf16 v[32:35], v[220:223], v[220:223], 0
    ds_read_b64_tr_b16 v[96:97], v2 offset:0
    v_fmac_f32 v50, v36, v80
    v_mfma_f32_16x16x32_bf16 v[156:159], v[100:103], v[132:135], v[156:159]
    ds_read_b128 v[116:119], v0 offset:35072
    v_fmac_f32 v50, v37, v81
    v_fmac_f32 v50, v38, v82
    v_fmac_f32 v50, v39, v83
    v_mfma_f32_16x16x32_bf16 v[36:39], a[28:31], v[220:223], 0
    buffer_load_dwordx4 v7, s[24:27], 0 offen  lds
    v_fmac_f32 v51, v29, v61
    v_mfma_f32_16x16x32_bf16 v[164:167], v[100:103], v[136:139], v[164:167]
    ds_read_b64_tr_b16 v[98:99], v2 offset:1024
    v_fmac_f32 v51, v32, v84
    v_mfma_f32_16x16x32_bf16 v[28:31], a[92:95], v[220:223], 0
    ds_read_b128 v[120:123], v0 offset:36096
    v_fmac_f32 v51, v33, v85
    v_mfma_f32_16x16x32_bf16 v[168:171], v[104:107], v[136:139], v[168:171]
    v_fmac_f32 v51, v34, v86
    v_fmac_f32 v51, v35, v87
    v_mfma_f32_16x16x32_bf16 v[32:35], a[156:159], v[220:223], 0
    v_fmac_f32 v51, v36, v68
    v_fmac_f32 v51, v37, v69
    v_fmac_f32 v51, v38, v70
    v_fmac_f32 v51, v39, v71
    v_mfma_f32_16x16x32_bf16 v[36:39], a[220:223], v[220:223], 0
    v_fmac_f32 v51, v28, v72
    v_fmac_f32 v51, v29, v73
L_step80:
    s_waitcnt vmcnt(7) lgkmcnt(0)
    v_mfma_f32_16x16x32_bf16 v[140:143], v[92:95], v[108:111], v[140:143]
    s_barrier
    ds_read_b64_tr_b16 v[100:101], v4 offset:8192
    ds_read_b128 v[124:127], v0 offset:37152
    s_add_u32 m0, s55, 32768
    s_mov_b32 s56, 655360
    v_mfma_f32_16x16x32_bf16 v[148:151], v[92:95], v[112:115], v[148:151]
    buffer_load_dwordx4 v5, s[28:31], s56 offen  lds
    v_fmac_f32 v51, v30, v74
    v_mfma_f32_16x16x32_bf16 v[152:155], v[96:99], v[112:115], v[152:155]
    ds_read_b64_tr_b16 v[102:103], v4 offset:9216
    v_fmac_f32 v51, v31, v75
    v_mfma_f32_16x16x32_bf16 v[144:147], v[96:99], v[108:111], v[144:147]
    ds_read_b128 v[128:131], v0 offset:38176
    v_fmac_f32 v51, v32, v76
    v_mfma_f32_16x16x32_bf16 v[28:31], v[172:175], v[224:227], 0
    ds_read_b128 v[88:91], v12 offset:20480
    ds_read_b64_tr_b16 v[104:105], v2 offset:8192
    v_mfma_f32_16x16x32_bf16 v[160:163], v[96:99], v[116:119], v[160:163]
    buffer_load_dwordx4 v5, s[28:31], s56 offen offset:1024  lds
    s_add_u32 m0, s54, 0
    v_add_u32_dpp v7, v20, v6 quad_perm:[3,3,3,3] row_mask:0xf bank_mask:0xf
    v_fmac_f32 v51, v33, v77
    v_fmac_f32 v51, v34, v78
    v_fmac_f32 v51, v35, v79
    v_mfma_f32_16x16x32_bf16 v[32:35], v[224:227], v[224:227], 0
    ds_read_b128 v[132:135], v0 offset:39200
    v_fmac_f32 v51, v36, v80
    v_mfma_f32_16x16x32_bf16 v[156:159], v[92:95], v[116:119], v[156:159]
    ds_read_b64_tr_b16 v[106:107], v2 offset:9216
    v_fmac_f32 v51, v37, v81
    v_fmac_f32 v51, v38, v82
    v_fmac_f32 v51, v39, v83
    v_mfma_f32_16x16x32_bf16 v[36:39], a[32:35], v[224:227], 0
    buffer_load_dwordx4 v7, s[24:27], 0 offen  lds
    v_add_u32 v190, L_end-L_pc-4096, v189
    v_mfma_f32_16x16x32_bf16 v[164:167], v[92:95], v[120:123], v[164:167]
    ds_read_b128 v[136:139], v0 offset:40224
    v_fmac_f32 v52, v30, v61
    v_mfma_f32_16x16x32_bf16 v[28:31], a[96:99], v[224:227], 0
    v_fmac_f32 v52, v32, v84
    v_fmac_f32 v52, v33, v85
    v_mfma_f32_16x16x32_bf16 v[168:171], v[96:99], v[120:123], v[168:171]
    global_load_dword v190, v190, s[62:63]
    v_fmac_f32 v52, v34, v86
    v_fmac_f32 v52, v35, v87
    v_mfma_f32_16x16x32_bf16 v[32:35], a[160:163], v[224:227], 0
    v_fmac_f32 v52, v36, v68
    v_fmac_f32 v52, v37, v69
    v_fmac_f32 v52, v38, v70
    v_fmac_f32 v52, v39, v71
    v_mfma_f32_16x16x32_bf16 v[36:39], a[224:227], v[224:227], 0
    v_fmac_f32 v52, v28, v72
    v_fmac_f32 v52, v29, v73
L_step81:
    s_waitcnt vmcnt(8) lgkmcnt(0)
    v_mfma_f32_16x16x32_bf16 v[140:143], v[100:103], v[124:127], v[140:143]
    s_barrier
    ds_read_b64_tr_b16 v[92:93], v4 offset:16384
    s_add_u32 m0, s55, 0
    s_mov_b32 s56, 663552
    v_mfma_f32_16x16x32_bf16 v[148:151], v[100:103], v[128:131], v[148:151]
    buffer_load_dwordx4 v5, s[28:31], s56 offen  lds
    v_fmac_f32 v52, v30, v74
    v_mfma_f32_16x16x32_bf16 v[152:155], v[104:107], v[128:131], v[152:155]
    ds_read_b128 v[108:111], v0 offset:41280
    v_fmac_f32 v52, v31, v75
    v_mfma_f32_16x16x32_bf16 v[144:147], v[104:107], v[124:127], v[144:147]
    ds_read_b64_tr_b16 v[94:95], v4 offset:17408
    v_fmac_f32 v52, v32, v76
    v_mfma_f32_16x16x32_bf16 v[28:31], v[176:179], v[228:231], 0
    ds_read_b128 v[112:115], v0 offset:42304
    v_fmac_f32 v52, v33, v77
    v_mfma_f32_16x16x32_bf16 v[160:163], v[104:107], v[132:135], v[160:163]
    buffer_load_dwordx4 v5, s[28:31], s56 offen offset:1024  lds
    s_add_u32 m0, s54, 4128
    v_add_u32_dpp v7, v21, v6 quad_perm:[3,3,3,3] row_mask:0xf bank_mask:0xf
    v_fmac_f32 v52, v34, v78
    v_fmac_f32 v52, v35, v79
    v_mfma_f32_16x16x32_bf16 v[32:35], v[228:231], v[228:231], 0
    ds_read_b64_tr_b16 v[96:97], v2 offset:16384
    v_fmac_f32 v52, v36, v80
    v_mfma_f32_16x16x32_bf16 v[156:159], v[100:103], v[132:135], v[156:159]
    ds_read_b128 v[116:119], v0 offset:43328
    v_fmac_f32 v52, v37, v81
    v_fmac_f32 v52, v38, v82
    v_fmac_f32 v52, v39, v83
    v_mfma_f32_16x16x32_bf16 v[36:39], a[36:39], v[228:231], 0
    buffer_load_dwordx4 v7, s[24:27], 0 offen  lds
    v_fmac_f32 v53, v30, v61
    v_mfma_f32_16x16x32_bf16 v[164:167], v[100:103], v[136:139], v[164:167]
    ds_read_b64_tr_b16 v[98:99], v2 offset:17408
    v_fmac_f32 v53, v32, v84
    v_mfma_f32_16x16x32_bf16 v[28:31], a[100:103], v[228:231], 0
    ds_read_b128 v[120:123], v0 offset:44352
    v_fmac_f32 v53, v33, v85
    v_mfma_f32_16x16x32_bf16 v[168:171], v[104:107], v[136:139], v[168:171]
    v_fmac_f32 v53, v34, v86
    v_fmac_f32 v53, v35, v87
    v_mfma_f32_16x16x32_bf16 v[32:35], a[164:167], v[228:231], 0
    v_fmac_f32 v53, v36, v68
    v_fmac_f32 v53, v37, v69
    v_fmac_f32 v53, v38, v70
    v_fmac_f32 v53, v39, v71
    v_mfma_f32_16x16x32_bf16 v[36:39], a[228:231], v[228:231], 0
    v_fmac_f32 v53, v28, v72
    v_fmac_f32 v53, v29, v73
L_step82:
    s_waitcnt vmcnt(8) lgkmcnt(0)
    v_mfma_f32_16x16x32_bf16 v[140:143], v[92:95], v[108:111], v[140:143]
    s_barrier
    ds_read_b64_tr_b16 v[100:101], v4 offset:24576
    s_add_u32 m0, s55, 8192
    s_mov_b32 s56, 671744
    v_mfma_f32_16x16x32_bf16 v[148:151], v[92:95], v[112:115], v[148:151]
    buffer_load_dwordx4 v5, s[28:31], s56 offen  lds
    v_fmac_f32 v53, v30, v74
    v_mfma_f32_16x16x32_bf16 v[152:155], v[96:99], v[112:115], v[152:155]
    ds_read_b128 v[124:127], v0 offset:45408
    v_fmac_f32 v53, v31, v75
    v_mfma_f32_16x16x32_bf16 v[144:147], v[96:99], v[108:111], v[144:147]
    ds_read_b64_tr_b16 v[102:103], v4 offset:25600
    v_fmac_f32 v53, v32, v76
    v_mfma_f32_16x16x32_bf16 v[28:31], v[180:183], v[232:235], 0
    ds_read_b128 v[128:131], v0 offset:46432
    v_fmac_f32 v53, v33, v77
    v_mfma_f32_16x16x32_bf16 v[160:163], v[96:99], v[116:119], v[160:163]
    buffer_load_dwordx4 v5, s[28:31], s56 offen offset:1024  lds
    s_add_u32 m0, s54, 8256
    v_add_u32_dpp v7, v22, v6 quad_perm:[3,3,3,3] row_mask:0xf bank_mask:0xf
    v_fmac_f32 v53, v34, v78
    v_fmac_f32 v53, v35, v79
    v_mfma_f32_16x16x32_bf16 v[32:35], v[232:235], v[232:235], 0
    ds_read_b64_tr_b16 v[104:105], v2 offset:24576
    v_fmac_f32 v53, v36, v80
    v_mfma_f32_16x16x32_bf16 v[156:159], v[92:95], v[116:119], v[156:159]
    ds_read_b128 v[132:135], v0 offset:47456
    v_fmac_f32 v53, v37, v81
    v_fmac_f32 v53, v38, v82
    v_fmac_f32 v53, v39, v83
    v_mfma_f32_16x16x32_bf16 v[36:39], a[40:43], v[232:235], 0
    buffer_load_dwordx4 v7, s[24:27], 0 offen  lds
    v_fmac_f32 v54, v30, v61
    v_mfma_f32_16x16x32_bf16 v[164:167], v[92:95], v[120:123], v[164:167]
    ds_read_b64_tr_b16 v[106:107], v2 offset:25600
    v_fmac_f32 v54, v32, v84
    v_mfma_f32_16x16x32_bf16 v[28:31], a[104:107], v[232:235], 0
    ds_read_b128 v[136:139], v0 offset:48480
    v_fmac_f32 v54, v33, v85
    v_mfma_f32_16x16x32_bf16 v[168:171], v[96:99], v[120:123], v[168:171]
    v_fmac_f32 v54, v34, v86
    v_fmac_f32 v54, v35, v87
    v_mfma_f32_16x16x32_bf16 v[32:35], a[168:171], v[232:235], 0
    v_fmac_f32 v54, v36, v68
    v_fmac_f32 v54, v37, v69
    v_fmac_f32 v54, v38, v70
    v_fmac_f32 v54, v39, v71
    v_mfma_f32_16x16x32_bf16 v[36:39], a[232:235], v[232:235], 0
    v_fmac_f32 v54, v28, v72
    v_fmac_f32 v54, v29, v73
L_step83:
    s_waitcnt vmcnt(8) lgkmcnt(0)
    v_mfma_f32_16x16x32_bf16 v[140:143], v[100:103], v[124:127], v[140:143]
    s_barrier
    ds_read_b64_tr_b16 v[92:93], v4 offset:32768
    s_add_u32 m0, s55, 16384
    s_mov_b32 s56, 679936
    v_mfma_f32_16x16x32_bf16 v[148:151], v[100:103], v[128:131], v[148:151]
    buffer_load_dwordx4 v5, s[28:31], s56 offen  lds
    v_fmac_f32 v54, v30, v74
    v_mfma_f32_16x16x32_bf16 v[152:155], v[104:107], v[128:131], v[152:155]
    ds_read_b128 v[108:111], v1 offset:0
    v_fmac_f32 v54, v31, v75
    v_mfma_f32_16x16x32_bf16 v[144:147], v[104:107], v[124:127], v[144:147]
    ds_read_b64_tr_b16 v[94:95], v4 offset:33792
    v_fmac_f32 v54, v32, v76
    v_mfma_f32_16x16x32_bf16 v[28:31], v[184:187], v[236:239], 0
    ds_read_b128 v[112:115], v1 offset:1024
    v_fmac_f32 v54, v33, v77
    v_mfma_f32_16x16x32_bf16 v[160:163], v[104:107], v[132:135], v[160:163]
    buffer_load_dwordx4 v5, s[28:31], s56 offen offset:1024  lds
    s_add_u32 m0, s54, 12384
    v_add_u32_dpp v7, v23, v6 quad_perm:[3,3,3,3] row_mask:0xf bank_mask:0xf
    v_fmac_f32 v54, v34, v78
    v_fmac_f32 v54, v35, v79
    v_mfma_f32_16x16x32_bf16 v[32:35], v[236:239], v[236:239], 0
    ds_read_b64_tr_b16 v[96:97], v2 offset:32768
    v_fmac_f32 v54, v36, v80
    v_mfma_f32_16x16x32_bf16 v[156:159], v[100:103], v[132:135], v[156:159]
    ds_read_b128 v[116:119], v1 offset:2048
    v_fmac_f32 v54, v37, v81
    v_fmac_f32 v54, v38, v82
    v_fmac_f32 v54, v39, v83
    v_mfma_f32_16x16x32_bf16 v[36:39], a[44:47], v[236:239], 0
    buffer_load_dwordx4 v7, s[24:27], 0 offen  lds
    v_fmac_f32 v55, v30, v61
    v_mfma_f32_16x16x32_bf16 v[164:167], v[100:103], v[136:139], v[164:167]
    ds_read_b64_tr_b16 v[98:99], v2 offset:33792
    v_fmac_f32 v55, v32, v84
    v_mfma_f32_16x16x32_bf16 v[28:31], a[108:111], v[236:239], 0
    ds_read_b128 v[120:123], v1 offset:3072
    v_fmac_f32 v55, v33, v85
    v_mfma_f32_16x16x32_bf16 v[168:171], v[104:107], v[136:139], v[168:171]
    v_fmac_f32 v55, v34, v86
    v_fmac_f32 v55, v35, v87
    v_mfma_f32_16x16x32_bf16 v[32:35], a[172:175], v[236:239], 0
    v_fmac_f32 v55, v36, v68
    v_fmac_f32 v55, v37, v69
    v_fmac_f32 v55, v38, v70
    v_fmac_f32 v55, v39, v71
    v_mfma_f32_16x16x32_bf16 v[36:39], a[236:239], v[236:239], 0
    v_fmac_f32 v55, v28, v72
    v_fmac_f32 v55, v29, v73
L_step84:
    s_waitcnt vmcnt(7) lgkmcnt(0)
    v_mfma_f32_16x16x32_bf16 v[140:143], v[92:95], v[108:111], v[140:143]
    s_barrier
    ds_read_b64_tr_b16 v[100:101], v4 offset:0
    s_add_u32 m0, s55, 24576
    s_mov_b32 s56, 688128
    v_mfma_f32_16x16x32_bf16 v[148:151], v[92:95], v[112:115], v[148:151]
    buffer_load_dwordx4 v5, s[28:31], s56 offen  lds
    v_fmac_f32 v55, v30, v74
    v_mfma_f32_16x16x32_bf16 v[152:155], v[96:99], v[112:115], v[152:155]
    ds_read_b128 v[124:127], v1 offset:4128
    v_fmac_f32 v55, v31, v75
    v_mfma_f32_16x16x32_bf16 v[144:147], v[96:99], v[108:111], v[144:147]
    ds_read_b64_tr_b16 v[102:103], v4 offset:1024
    v_fmac_f32 v55, v32, v76
    v_mfma_f32_16x16x32_bf16 v[28:31], v[172:175], v[240:243], 0
    ds_read_b128 v[128:131], v1 offset:5152
    v_fmac_f32 v55, v33, v77
    v_mfma_f32_16x16x32_bf16 v[160:163], v[96:99], v[116:119], v[160:163]
    buffer_load_dwordx4 v5, s[28:31], s56 offen offset:1024  lds
    v_fmac_f32 v55, v34, v78
    v_fmac_f32 v55, v35, v79
    v_mfma_f32_16x16x32_bf16 v[32:35], v[240:243], v[240:243], 0
    ds_read_b64_tr_b16 v[104:105], v2 offset:0
    v_fmac_f32 v55, v36, v80
    v_mfma_f32_16x16x32_bf16 v[156:159], v[92:95], v[116:119], v[156:159]
    ds_read_b128 v[132:135], v1 offset:6176
    v_fmac_f32 v55, v37, v81
    v_fmac_f32 v55, v38, v82
    v_fmac_f32 v55, v39, v83
    v_mfma_f32_16x16x32_bf16 v[36:39], a[48:51], v[240:243], 0
    ds_read_b64_tr_b16 v[106:107], v2 offset:1024
    v_fmac_f32 v56, v31, v61
    v_mfma_f32_16x16x32_bf16 v[164:167], v[92:95], v[120:123], v[164:167]
    ds_read_b128 v[136:139], v1 offset:7200
    v_fmac_f32 v56, v32, v84
    v_mfma_f32_16x16x32_bf16 v[28:31], a[112:115], v[240:243], 0
    v_fmac_f32 v56, v33, v85
    v_fmac_f32 v56, v34, v86
    v_mfma_f32_16x16x32_bf16 v[168:171], v[96:99], v[120:123], v[168:171]
    v_fmac_f32 v56, v35, v87
    v_fmac_f32 v56, v36, v68
    v_mfma_f32_16x16x32_bf16 v[32:35], a[176:179], v[240:243], 0
    v_fmac_f32 v56, v37, v69
    v_fmac_f32 v56, v38, v70
    v_fmac_f32 v56, v39, v71
    v_mfma_f32_16x16x32_bf16 v[36:39], a[240:243], v[240:243], 0
    v_fmac_f32 v56, v28, v72
    v_fmac_f32 v56, v29, v73
L_step85:
    s_waitcnt vmcnt(6) lgkmcnt(0)
    v_mfma_f32_16x16x32_bf16 v[140:143], v[100:103], v[124:127], v[140:143]
    s_barrier
    ds_read_b64_tr_b16 v[92:93], v4 offset:8192
    s_add_u32 m0, s55, 32768
    s_mov_b32 s56, 696320
    v_mfma_f32_16x16x32_bf16 v[148:151], v[100:103], v[128:131], v[148:151]
    buffer_load_dwordx4 v5, s[28:31], s56 offen  lds
    v_fmac_f32 v56, v30, v74
    v_mfma_f32_16x16x32_bf16 v[152:155], v[104:107], v[128:131], v[152:155]
    ds_read_b128 v[108:111], v1 offset:8256
    v_fmac_f32 v56, v31, v75
    v_mfma_f32_16x16x32_bf16 v[144:147], v[104:107], v[124:127], v[144:147]
    ds_read_b64_tr_b16 v[94:95], v4 offset:9216
    v_fmac_f32 v56, v32, v76
    v_mfma_f32_16x16x32_bf16 v[28:31], v[176:179], v[244:247], 0
    ds_read_b128 v[112:115], v1 offset:9280
    v_fmac_f32 v56, v33, v77
    v_mfma_f32_16x16x32_bf16 v[160:163], v[104:107], v[132:135], v[160:163]
    buffer_load_dwordx4 v5, s[28:31], s56 offen offset:1024  lds
    v_fmac_f32 v56, v34, v78
    v_fmac_f32 v56, v35, v79
    v_mfma_f32_16x16x32_bf16 v[32:35], v[244:247], v[244:247], 0
    ds_read_b64_tr_b16 v[96:97], v2 offset:8192
    v_fmac_f32 v56, v36, v80
    v_mfma_f32_16x16x32_bf16 v[156:159], v[100:103], v[132:135], v[156:159]
    ds_read_b128 v[116:119], v1 offset:10304
    v_fmac_f32 v56, v37, v81
    v_fmac_f32 v56, v38, v82
    v_fmac_f32 v56, v39, v83
    v_mfma_f32_16x16x32_bf16 v[36:39], a[52:55], v[244:247], 0
    ds_read_b64_tr_b16 v[98:99], v2 offset:9216
    v_fmac_f32 v57, v31, v61
    v_mfma_f32_16x16x32_bf16 v[164:167], v[100:103], v[136:139], v[164:167]
    ds_read_b128 v[120:123], v1 offset:11328
    v_fmac_f32 v57, v32, v84
    v_mfma_f32_16x16x32_bf16 v[28:31], a[116:119], v[244:247], 0
    v_fmac_f32 v57, v33, v85
    v_fmac_f32 v57, v34, v86
    v_mfma_f32_16x16x32_bf16 v[168:171], v[104:107], v[136:139], v[168:171]
    v_fmac_f32 v57, v35, v87
    v_fmac_f32 v57, v36, v68
    v_mfma_f32_16x16x32_bf16 v[32:35], a[180:183], v[244:247], 0
    v_fmac_f32 v57, v37, v69
    v_fmac_f32 v57, v38, v70
    v_fmac_f32 v57, v39, v71
    v_mfma_f32_16x16x32_bf16 v[36:39], a[244:247], v[244:247], 0
    v_fmac_f32 v57, v28, v72
    v_fmac_f32 v57, v29, v73
L_step86:
    s_waitcnt vmcnt(5) lgkmcnt(0)
    v_mfma_f32_16x16x32_bf16 v[140:143], v[92:95], v[108:111], v[140:143]
    s_barrier
    ds_read_b64_tr_b16 v[100:101], v4 offset:16384
    s_add_u32 m0, s55, 0
    s_mov_b32 s56, 704512
    v_mfma_f32_16x16x32_bf16 v[148:151], v[92:95], v[112:115], v[148:151]
    buffer_load_dwordx4 v5, s[28:31], s56 offen  lds
    v_fmac_f32 v57, v30, v74
    v_mfma_f32_16x16x32_bf16 v[152:155], v[96:99], v[112:115], v[152:155]
    ds_read_b128 v[124:127], v1 offset:12384
    v_fmac_f32 v57, v31, v75
    v_mfma_f32_16x16x32_bf16 v[144:147], v[96:99], v[108:111], v[144:147]
    ds_read_b64_tr_b16 v[102:103], v4 offset:17408
    v_fmac_f32 v57, v32, v76
    v_mfma_f32_16x16x32_bf16 v[28:31], v[180:183], v[248:251], 0
    ds_read_b128 v[128:131], v1 offset:13408
    v_fmac_f32 v57, v33, v77
    v_mfma_f32_16x16x32_bf16 v[160:163], v[96:99], v[116:119], v[160:163]
    buffer_load_dwordx4 v5, s[28:31], s56 offen offset:1024  lds
    v_fmac_f32 v57, v34, v78
    v_fmac_f32 v57, v35, v79
    v_mfma_f32_16x16x32_bf16 v[32:35], v[248:251], v[248:251], 0
    ds_read_b64_tr_b16 v[104:105], v2 offset:16384
    v_fmac_f32 v57, v36, v80
    v_mfma_f32_16x16x32_bf16 v[156:159], v[92:95], v[116:119], v[156:159]
    ds_read_b128 v[132:135], v1 offset:14432
    v_fmac_f32 v57, v37, v81
    v_fmac_f32 v57, v38, v82
    v_fmac_f32 v57, v39, v83
    v_mfma_f32_16x16x32_bf16 v[36:39], a[56:59], v[248:251], 0
    ds_read_b64_tr_b16 v[106:107], v2 offset:17408
    v_fmac_f32 v58, v31, v61
    v_mfma_f32_16x16x32_bf16 v[164:167], v[92:95], v[120:123], v[164:167]
    ds_read_b128 v[136:139], v1 offset:15456
    v_fmac_f32 v58, v32, v84
    v_mfma_f32_16x16x32_bf16 v[28:31], a[120:123], v[248:251], 0
    v_fmac_f32 v58, v33, v85
    v_fmac_f32 v58, v34, v86
    v_mfma_f32_16x16x32_bf16 v[168:171], v[96:99], v[120:123], v[168:171]
    v_fmac_f32 v58, v35, v87
    v_fmac_f32 v58, v36, v68
    v_mfma_f32_16x16x32_bf16 v[32:35], a[184:187], v[248:251], 0
    v_fmac_f32 v58, v37, v69
    v_fmac_f32 v58, v38, v70
    v_fmac_f32 v58, v39, v71
    v_mfma_f32_16x16x32_bf16 v[36:39], a[248:251], v[248:251], 0
    v_fmac_f32 v58, v28, v72
    v_fmac_f32 v58, v29, v73
L_step87:
    s_waitcnt vmcnt(4) lgkmcnt(0)
    v_mfma_f32_16x16x32_bf16 v[140:143], v[100:103], v[124:127], v[140:143]
    s_barrier
    ds_read_b64_tr_b16 v[92:93], v4 offset:24576
    s_add_u32 m0, s55, 8192
    s_mov_b32 s56, 712704
    s_mov_b32 vcc_lo, 0xf000f000
    s_mov_b32 vcc_hi, 0xf000f000
    v_add_u32 v9, 49536, v8
    v_subrev_u32 v17, 49536, v8
    v_cndmask_b32 v9, v9, v17, vcc
    v_xad_u32 v10, v11, 0, v9
    v_mfma_f32_16x16x32_bf16 v[148:151], v[100:103], v[128:131], v[148:151]
    ds_read_b128 v[20:23], v10 offset:0
    v_fmac_f32 v58, v30, v74
    v_mfma_f32_16x16x32_bf16 v[152:155], v[104:107], v[128:131], v[152:155]
    buffer_load_dwordx4 v5, s[28:31], s56 offen  lds
    v_fmac_f32 v58, v31, v75
    v_mfma_f32_16x16x32_bf16 v[144:147], v[104:107], v[124:127], v[144:147]
    ds_read_b128 v[108:111], v1 offset:16512
    v_fmac_f32 v58, v32, v76
    v_mfma_f32_16x16x32_bf16 v[28:31], v[184:187], v[252:255], 0
    ds_read_b64_tr_b16 v[94:95], v4 offset:25600
    v_fmac_f32 v58, v33, v77
    v_mfma_f32_16x16x32_bf16 v[160:163], v[104:107], v[132:135], v[160:163]
    ds_read_b128 v[112:115], v1 offset:17536
    v_fmac_f32 v58, v34, v78
    v_fmac_f32 v58, v35, v79
    v_mfma_f32_16x16x32_bf16 v[32:35], v[252:255], v[252:255], 0
    buffer_load_dwordx4 v5, s[28:31], s56 offen offset:1024  lds
    v_fmac_f32 v58, v36, v80
    v_mfma_f32_16x16x32_bf16 v[156:159], v[100:103], v[132:135], v[156:159]
    ds_read_b64_tr_b16 v[96:97], v2 offset:24576
    v_fmac_f32 v58, v37, v81
    v_fmac_f32 v58, v38, v82
    v_fmac_f32 v58, v39, v83
    v_mfma_f32_16x16x32_bf16 v[36:39], a[60:63], v[252:255], 0
    ds_read_b128 v[116:119], v1 offset:18560
    v_fmac_f32 v59, v31, v61
    v_mfma_f32_16x16x32_bf16 v[164:167], v[100:103], v[136:139], v[164:167]
    ds_read_b64_tr_b16 v[98:99], v2 offset:25600
    v_fmac_f32 v59, v32, v84
    v_mfma_f32_16x16x32_bf16 v[28:31], a[124:127], v[252:255], 0
    ds_read_b128 v[120:123], v1 offset:19584
    v_fmac_f32 v59, v33, v85
    v_mfma_f32_16x16x32_bf16 v[168:171], v[104:107], v[136:139], v[168:171]
    v_fmac_f32 v59, v34, v86
    v_fmac_f32 v59, v35, v87
    v_mfma_f32_16x16x32_bf16 v[32:35], a[188:191], v[252:255], 0
    ds_read_b128 v[84:87], v12 offset:19456
    v_fmac_f32 v59, v36, v68
    v_fmac_f32 v59, v37, v69
    v_fmac_f32 v59, v38, v70
    v_fmac_f32 v59, v39, v71
    v_mfma_f32_16x16x32_bf16 v[36:39], a[252:255], v[252:255], 0
    ds_read_b128 v[68:71], v12 offset:15360
    v_fmac_f32 v59, v28, v72
L_step88:
    s_waitcnt vmcnt(4) lgkmcnt(2)
    v_mfma_f32_16x16x32_bf16 v[140:143], v[92:95], v[108:111], v[140:143]
    s_barrier
    ds_read_b64_tr_b16 v[100:101], v4 offset:32768
    s_add_u32 m0, s55, 16384
    s_mov_b32 s56, 720896
    v_mfma_f32_16x16x32_bf16 v[148:151], v[92:95], v[112:115], v[148:151]
    buffer_load_dwordx4 v5, s[28:31], s56 offen  lds
    v_fmac_f32 v59, v29, v73
    v_mfma_f32_16x16x32_bf16 v[152:155], v[96:99], v[112:115], v[152:155]
    ds_read_b128 v[124:127], v1 offset:20640
    v_fmac_f32 v59, v30, v74
    v_fmac_f32 v59, v31, v75
    v_mfma_f32_16x16x32_bf16 v[28:31], v[172:175], v[20:23], 0
    ds_read_b128 v[72:75], v12 offset:16384
    v_fmac_f32 v59, v32, v76
    v_mfma_f32_16x16x32_bf16 v[144:147], v[96:99], v[108:111], v[144:147]
    ds_read_b128 v[24:27], v10 offset:64
    v_fmac_f32 v59, v33, v77
    v_fmac_f32 v59, v34, v78
    v_fmac_f32 v59, v35, v79
    v_mfma_f32_16x16x32_bf16 v[32:35], v[20:23], v[20:23], 0
    ds_read_b128 v[76:79], v12 offset:17408
    buffer_load_dwordx4 v5, s[28:31], s56 offen offset:1024  lds
    v_mfma_f32_16x16x32_bf16 v[160:163], v[96:99], v[116:119], v[160:163]
    ds_read_b64_tr_b16 v[102:103], v4 offset:33792
    v_fmac_f32 v59, v36, v80
    v_fmac_f32 v59, v37, v81
    v_fmac_f32 v59, v38, v82
    v_fmac_f32 v59, v39, v83
    v_mfma_f32_16x16x32_bf16 v[36:39], a[0:3], v[20:23], 0
    ds_read_b128 v[80:83], v12 offset:18432
    ds_read_b128 v[128:131], v1 offset:21664
    v_mfma_f32_16x16x32_bf16 v[156:159], v[92:95], v[116:119], v[156:159]
    ds_read_b64_tr_b16 v[104:105], v2 offset:32768
    v_fmac_f32 v44, v28, v60
    v_mfma_f32_16x16x32_bf16 v[28:31], a[64:67], v[20:23], 0
    ds_read_b128 v[132:135], v1 offset:22688
    v_fmac_f32 v44, v32, v88
    v_mfma_f32_16x16x32_bf16 v[164:167], v[92:95], v[120:123], v[164:167]
    ds_read_b64_tr_b16 v[106:107], v2 offset:33792
    v_fmac_f32 v44, v33, v89
    v_fmac_f32 v44, v34, v90
    v_fmac_f32 v44, v35, v91
    v_mfma_f32_16x16x32_bf16 v[32:35], a[128:131], v[20:23], 0
    ds_read_b128 v[136:139], v1 offset:23712
    s_waitcnt lgkmcnt(12)
    v_fmac_f32 v44, v36, v68
    v_mfma_f32_16x16x32_bf16 v[168:171], v[96:99], v[120:123], v[168:171]
    v_fmac_f32 v44, v37, v69
    v_fmac_f32 v44, v38, v70
    v_fmac_f32 v44, v39, v71
    v_mfma_f32_16x16x32_bf16 v[36:39], a[192:195], v[20:23], 0
    s_waitcnt lgkmcnt(9)
    v_fmac_f32 v44, v28, v72
    v_fmac_f32 v44, v29, v73
    v_fmac_f32 v44, v30, v74
    v_fmac_f32 v44, v31, v75
    v_mfma_f32_16x16x32_bf16 v[28:31], v[192:195], v[20:23], 0
    s_waitcnt lgkmcnt(7)
    v_fmac_f32 v44, v32, v76
L_step89:
    s_waitcnt vmcnt(4) lgkmcnt(0)
    v_mfma_f32_16x16x32_bf16 v[140:143], v[100:103], v[124:127], v[140:143]
    s_barrier
    ds_read_b64_tr_b16 v[92:93], v4 offset:0
    s_add_u32 m0, s55, 24576
    s_mov_b32 s56, 729088
    v_mfma_f32_16x16x32_bf16 v[148:151], v[100:103], v[128:131], v[148:151]
    buffer_load_dwordx4 v5, s[28:31], s56 offen  lds
    v_fmac_f32 v44, v33, v77
    v_mfma_f32_16x16x32_bf16 v[152:155], v[104:107], v[128:131], v[152:155]
    ds_read_b128 v[108:111], v1 offset:24768
    v_fmac_f32 v44, v34, v78
    v_fmac_f32 v44, v35, v79
    v_mfma_f32_16x16x32_bf16 v[32:35], v[176:179], v[24:27], 0
    ds_read_b128 v[20:23], v10 offset:128
    v_fmac_f32 v44, v36, v80
    v_mfma_f32_16x16x32_bf16 v[144:147], v[104:107], v[124:127], v[144:147]
    ds_read_b64_tr_b16 v[94:95], v4 offset:1024
    v_fmac_f32 v44, v37, v81
    v_fmac_f32 v44, v38, v82
    v_fmac_f32 v44, v39, v83
    v_mfma_f32_16x16x32_bf16 v[36:39], v[24:27], v[24:27], 0
    buffer_load_dwordx4 v5, s[28:31], s56 offen offset:1024  lds
    v_fmac_f32 v44, v28, v84
    v_mfma_f32_16x16x32_bf16 v[160:163], v[104:107], v[132:135], v[160:163]
    ds_read_b128 v[112:115], v1 offset:25792
    v_fmac_f32 v44, v29, v85
    v_fmac_f32 v44, v30, v86
    v_fmac_f32 v44, v31, v87
    v_mfma_f32_16x16x32_bf16 v[28:31], a[4:7], v[24:27], 0
    ds_read_b64_tr_b16 v[96:97], v2 offset:0
    v_fmac_f32 v45, v32, v60
    v_mfma_f32_16x16x32_bf16 v[156:159], v[100:103], v[132:135], v[156:159]
    ds_read_b128 v[116:119], v1 offset:26816
    v_fmac_f32 v45, v36, v88
    v_mfma_f32_16x16x32_bf16 v[32:35], a[68:71], v[24:27], 0
    ds_read_b64_tr_b16 v[98:99], v2 offset:1024
    v_fmac_f32 v45, v37, v89
    v_fmac_f32 v45, v38, v90
    v_fmac_f32 v45, v39, v91
    v_mfma_f32_16x16x32_bf16 v[36:39], a[132:135], v[24:27], 0
    ds_read_b128 v[120:123], v1 offset:27840
    v_fmac_f32 v45, v28, v68
    v_mfma_f32_16x16x32_bf16 v[164:167], v[100:103], v[136:139], v[164:167]
    v_fmac_f32 v45, v29, v69
    v_fmac_f32 v45, v30, v70
    v_fmac_f32 v45, v31, v71
    v_mfma_f32_16x16x32_bf16 v[28:31], a[196:199], v[24:27], 0
    v_fmac_f32 v45, v32, v72
    v_fmac_f32 v45, v33, v73
    v_mfma_f32_16x16x32_bf16 v[168:171], v[104:107], v[136:139], v[168:171]
    v_fmac_f32 v45, v34, v74
    v_fmac_f32 v45, v35, v75
    v_mfma_f32_16x16x32_bf16 v[32:35], v[196:199], v[24:27], 0
    v_fmac_f32 v45, v36, v76
    v_fmac_f32 v45, v37, v77
    v_fmac_f32 v45, v38, v78
    v_fmac_f32 v45, v39, v79
    s_waitcnt lgkmcnt(6)
    v_mfma_f32_16x16x32_bf16 v[36:39], v[180:183], v[20:23], 0
    ds_read_b128 v[24:27], v10 offset:192
    v_fmac_f32 v45, v28, v80
L_step90:
    s_waitcnt vmcnt(4) lgkmcnt(1)
    v_mfma_f32_16x16x32_bf16 v[140:143], v[92:95], v[108:111], v[140:143]
    s_barrier
    ds_read_b64_tr_b16 v[100:101], v4 offset:8192
    s_add_u32 m0, s55, 32768
    s_mov_b32 s56, 737280
    v_mfma_f32_16x16x32_bf16 v[148:151], v[92:95], v[112:115], v[148:151]
    buffer_load_dwordx4 v5, s[28:31], s56 offen  lds
    v_fmac_f32 v45, v29, v81
    v_mfma_f32_16x16x32_bf16 v[152:155], v[96:99], v[112:115], v[152:155]
    ds_read_b128 v[124:127], v1 offset:28896
    v_fmac_f32 v45, v30, v82
    v_fmac_f32 v45, v31, v83
    v_mfma_f32_16x16x32_bf16 v[28:31], v[20:23], v[20:23], 0
    ds_read_b64_tr_b16 v[102:103], v4 offset:9216
    v_fmac_f32 v45, v32, v84
    v_mfma_f32_16x16x32_bf16 v[144:147], v[96:99], v[108:111], v[144:147]
    ds_read_b128 v[128:131], v1 offset:29920
    v_fmac_f32 v45, v33, v85
    v_fmac_f32 v45, v34, v86
    v_fmac_f32 v45, v35, v87
    v_mfma_f32_16x16x32_bf16 v[32:35], a[8:11], v[20:23], 0
    buffer_load_dwordx4 v5, s[28:31], s56 offen offset:1024  lds
    v_add_u32 v190, L_end-L_pc-4096, v189
    v_mfma_f32_16x16x32_bf16 v[160:163], v[96:99], v[116:119], v[160:163]
    ds_read_b64_tr_b16 v[104:105], v2 offset:8192
    v_fmac_f32 v46, v36, v60
    v_mfma_f32_16x16x32_bf16 v[36:39], a[72:75], v[20:23], 0
    ds_read_b128 v[132:135], v1 offset:30944
    v_fmac_f32 v46, v28, v88
    v_mfma_f32_16x16x32_bf16 v[156:159], v[92:95], v[116:119], v[156:159]
    ds_read_b64_tr_b16 v[106:107], v2 offset:9216
    v_fmac_f32 v46, v29, v89
    v_fmac_f32 v46, v30, v90
    v_fmac_f32 v46, v31, v91
    v_mfma_f32_16x16x32_bf16 v[28:31], a[136:139], v[20:23], 0
    global_load_dword v190, v190, s[62:63]
    v_fmac_f32 v46, v32, v68
    v_mfma_f32_16x16x32_bf16 v[164:167], v[92:95], v[120:123], v[164:167]
    ds_read_b128 v[136:139], v1 offset:31968
    v_fmac_f32 v46, v33, v69
    v_fmac_f32 v46, v34, v70
    v_fmac_f32 v46, v35, v71
    v_mfma_f32_16x16x32_bf16 v[32:35], a[200:203], v[20:23], 0
    v_fmac_f32 v46, v36, v72
    v_fmac_f32 v46, v37, v73
    v_mfma_f32_16x16x32_bf16 v[168:171], v[96:99], v[120:123], v[168:171]
    v_fmac_f32 v46, v38, v74
    v_fmac_f32 v46, v39, v75
    v_mfma_f32_16x16x32_bf16 v[36:39], v[200:203], v[20:23], 0
    v_fmac_f32 v46, v28, v76
    v_fmac_f32 v46, v29, v77
    v_fmac_f32 v46, v30, v78
    v_fmac_f32 v46, v31, v79
    s_waitcnt lgkmcnt(8)
    v_mfma_f32_16x16x32_bf16 v[28:31], v[184:187], v[24:27], 0
    v_xad_u32 v10, v11, 48, v9
    v_fmac_f32 v46, v32, v80
L_step91:
    s_waitcnt vmcnt(5) lgkmcnt(0)
    v_mfma_f32_16x16x32_bf16 v[140:143], v[100:103], v[124:127], v[140:143]
    s_barrier
    ds_read_b128 v[20:23], v10 offset:256
    s_add_u32 m0, s55, 0
    s_mov_b32 s56, 745472
    v_mfma_f32_16x16x32_bf16 v[148:151], v[100:103], v[128:131], v[148:151]
    buffer_load_dwordx4 v5, s[28:31], s56 offen  lds
    v_fmac_f32 v46, v33, v81
    v_mfma_f32_16x16x32_bf16 v[152:155], v[104:107], v[128:131], v[152:155]
    ds_read_b64_tr_b16 v[92:93], v4 offset:16384
    v_fmac_f32 v46, v34, v82
    v_fmac_f32 v46, v35, v83
    v_mfma_f32_16x16x32_bf16 v[32:35], v[24:27], v[24:27], 0
    ds_read_b128 v[108:111], v1 offset:33024
    v_fmac_f32 v46, v36, v84
    v_mfma_f32_16x16x32_bf16 v[144:147], v[104:107], v[124:127], v[144:147]
    ds_read_b64_tr_b16 v[94:95], v4 offset:17408
    v_fmac_f32 v46, v37, v85
    v_fmac_f32 v46, v38, v86
    v_fmac_f32 v46, v39, v87
    v_mfma_f32_16x16x32_bf16 v[36:39], a[12:15], v[24:27], 0
    buffer_load_dwordx4 v5, s[28:31], s56 offen offset:1024  lds
    v_fmac_f32 v47, v28, v60
    v_mfma_f32_16x16x32_bf16 v[160:163], v[104:107], v[132:135], v[160:163]
    ds_read_b128 v[112:115], v1 offset:34048
    v_fmac_f32 v47, v32, v88
    v_mfma_f32_16x16x32_bf16 v[28:31], a[76:79], v[24:27], 0
    ds_read_b64_tr_b16 v[96:97], v2 offset:16384
    v_fmac_f32 v47, v33, v89
    v_mfma_f32_16x16x32_bf16 v[156:159], v[100:103], v[132:135], v[156:159]
    ds_read_b128 v[116:119], v1 offset:35072
    v_fmac_f32 v47, v34, v90
    v_fmac_f32 v47, v35, v91
    v_mfma_f32_16x16x32_bf16 v[32:35], a[140:143], v[24:27], 0
    ds_read_b64_tr_b16 v[98:99], v2 offset:17408
    v_fmac_f32 v47, v36, v68
    v_fmac_f32 v47, v37, v69
    v_fmac_f32 v47, v38, v70
    v_fmac_f32 v47, v39, v71
    v_mfma_f32_16x16x32_bf16 v[36:39], a[204:207], v[24:27], 0
    ds_read_b128 v[120:123], v1 offset:36096
    v_fmac_f32 v47, v28, v72
    v_mfma_f32_16x16x32_bf16 v[164:167], v[100:103], v[136:139], v[164:167]
    v_fmac_f32 v47, v29, v73
    v_fmac_f32 v47, v30, v74
    v_fmac_f32 v47, v31, v75
    v_mfma_f32_16x16x32_bf16 v[28:31], v[204:207], v[24:27], 0
    v_fmac_f32 v47, v32, v76
    v_fmac_f32 v47, v33, v77
    v_mfma_f32_16x16x32_bf16 v[168:171], v[104:107], v[136:139], v[168:171]
    v_fmac_f32 v47, v34, v78
    v_fmac_f32 v47, v35, v79
    s_waitcnt lgkmcnt(8)
    v_mfma_f32_16x16x32_bf16 v[32:35], v[172:175], v[20:23], 0
    ds_read_b128 v[24:27], v10 offset:320
    v_fmac_f32 v47, v36, v80
    v_fmac_f32 v47, v37, v81
    v_fmac_f32 v47, v38, v82
    v_fmac_f32 v47, v39, v83
    v_mfma_f32_16x16x32_bf16 v[36:39], v[20:23], v[20:23], 0
    v_fmac_f32 v47, v28, v84
    v_fmac_f32 v47, v29, v85
L_step92:
    s_waitcnt vmcnt(5) lgkmcnt(1)
    v_mfma_f32_16x16x32_bf16 v[140:143], v[92:95], v[108:111], v[140:143]
    s_barrier
    ds_read_b64_tr_b16 v[100:101], v4 offset:24576
    s_add_u32 m0, s55, 8192
    s_mov_b32 s56, 753664
    v_mfma_f32_16x16x32_bf16 v[148:151], v[92:95], v[112:115], v[148:151]
    buffer_load_dwordx4 v5, s[28:31], s56 offen  lds
    v_fmac_f32 v47, v30, v86
    v_mfma_f32_16x16x32_bf16 v[152:155], v[96:99], v[112:115], v[152:155]
    ds_read_b128 v[124:127], v1 offset:37152
    v_fmac_f32 v47, v31, v87
    v_mfma_f32_16x16x32_bf16 v[28:31], a[16:19], v[20:23], 0
    ds_read_b64_tr_b16 v[102:103], v4 offset:25600
    v_fmac_f32 v48, v33, v60
    v_mfma_f32_16x16x32_bf16 v[144:147], v[96:99], v[108:111], v[144:147]
    ds_read_b128 v[128:131], v1 offset:38176
    v_fmac_f32 v48, v36, v88
    v_mfma_f32_16x16x32_bf16 v[32:35], a[80:83], v[20:23], 0
    buffer_load_dwordx4 v5, s[28:31], s56 offen offset:1024  lds
    v_fmac_f32 v48, v37, v89
    v_mfma_f32_16x16x32_bf16 v[160:163], v[96:99], v[116:119], v[160:163]
    ds_read_b64_tr_b16 v[104:105], v2 offset:24576
    v_fmac_f32 v48, v38, v90
    v_fmac_f32 v48, v39, v91
    v_mfma_f32_16x16x32_bf16 v[36:39], a[144:147], v[20:23], 0
    ds_read_b128 v[132:135], v1 offset:39200
    v_fmac_f32 v48, v28, v68
    v_mfma_f32_16x16x32_bf16 v[156:159], v[92:95], v[116:119], v[156:159]
    ds_read_b64_tr_b16 v[106:107], v2 offset:25600
    v_fmac_f32 v48, v29, v69
    v_fmac_f32 v48, v30, v70
    v_fmac_f32 v48, v31, v71
    v_mfma_f32_16x16x32_bf16 v[28:31], a[208:211], v[20:23], 0
    ds_read_b128 v[136:139], v1 offset:40224
    v_fmac_f32 v48, v32, v72
    v_mfma_f32_16x16x32_bf16 v[164:167], v[92:95], v[120:123], v[164:167]
    v_fmac_f32 v48, v33, v73
    v_fmac_f32 v48, v34, v74
    v_fmac_f32 v48, v35, v75
    v_mfma_f32_16x16x32_bf16 v[32:35], v[208:211], v[20:23], 0
    v_fmac_f32 v48, v36, v76
    v_fmac_f32 v48, v37, v77
    v_mfma_f32_16x16x32_bf16 v[168:171], v[96:99], v[120:123], v[168:171]
    v_fmac_f32 v48, v38, v78
    v_fmac_f32 v48, v39, v79
    s_waitcnt lgkmcnt(8)
    v_mfma_f32_16x16x32_bf16 v[36:39], v[176:179], v[24:27], 0
    ds_read_b128 v[20:23], v10 offset:384
    v_fmac_f32 v48, v28, v80
    v_fmac_f32 v48, v29, v81
    v_fmac_f32 v48, v30, v82
    v_fmac_f32 v48, v31, v83
    v_mfma_f32_16x16x32_bf16 v[28:31], v[24:27], v[24:27], 0
    v_fmac_f32 v48, v32, v84
    v_fmac_f32 v48, v33, v85
L_step93:
    s_waitcnt vmcnt(5) lgkmcnt(1)
    v_mfma_f32_16x16x32_bf16 v[140:143], v[100:103], v[124:127], v[140:143]
    s_barrier
    ds_read_b64_tr_b16 v[92:93], v4 offset:32768
    s_add_u32 m0, s55, 16384
    s_mov_b32 s56, 761856
    v_mfma_f32_16x16x32_bf16 v[148:151], v[100:103], v[128:131], v[148:151]
    buffer_load_dwordx4 v5, s[28:31], s56 offen  lds
    v_fmac_f32 v48, v34, v86
    v_mfma_f32_16x16x32_bf16 v[152:155], v[104:107], v[128:131], v[152:155]
    ds_read_b128 v[108:111], v1 offset:41280
    v_fmac_f32 v48, v35, v87
    v_mfma_f32_16x16x32_bf16 v[32:35], a[20:23], v[24:27], 0
    ds_read_b64_tr_b16 v[94:95], v4 offset:33792
    v_fmac_f32 v49, v37, v60
    v_mfma_f32_16x16x32_bf16 v[144:147], v[104:107], v[124:127], v[144:147]
    ds_read_b128 v[112:115], v1 offset:42304
    v_fmac_f32 v49, v28, v88
    v_mfma_f32_16x16x32_bf16 v[36:39], a[84:87], v[24:27], 0
    buffer_load_dwordx4 v5, s[28:31], s56 offen offset:1024  lds
    v_fmac_f32 v49, v29, v89
    v_mfma_f32_16x16x32_bf16 v[160:163], v[104:107], v[132:135], v[160:163]
    ds_read_b64_tr_b16 v[96:97], v2 offset:32768
    v_fmac_f32 v49, v30, v90
    v_fmac_f32 v49, v31, v91
    v_mfma_f32_16x16x32_bf16 v[28:31], a[148:151], v[24:27], 0
    ds_read_b128 v[116:119], v1 offset:43328
    v_fmac_f32 v49, v32, v68
    v_mfma_f32_16x16x32_bf16 v[156:159], v[100:103], v[132:135], v[156:159]
    ds_read_b64_tr_b16 v[98:99], v2 offset:33792
    v_fmac_f32 v49, v33, v69
    v_fmac_f32 v49, v34, v70
    v_fmac_f32 v49, v35, v71
    v_mfma_f32_16x16x32_bf16 v[32:35], a[212:215], v[24:27], 0
    ds_read_b128 v[120:123], v1 offset:44352
    v_fmac_f32 v49, v36, v72
    v_fmac_f32 v49, v37, v73
    v_fmac_f32 v49, v38, v74
    v_fmac_f32 v49, v39, v75
    v_mfma_f32_16x16x32_bf16 v[36:39], v[212:215], v[24:27], 0
    v_fmac_f32 v49, v28, v76
    v_fmac_f32 v49, v29, v77
    v_mfma_f32_16x16x32_bf16 v[164:167], v[100:103], v[136:139], v[164:167]
    v_fmac_f32 v49, v30, v78
    v_fmac_f32 v49, v31, v79
    s_waitcnt lgkmcnt(8)
    v_mfma_f32_16x16x32_bf16 v[28:31], v[180:183], v[20:23], 0
    ds_read_b128 v[24:27], v10 offset:448
    v_fmac_f32 v49, v32, v80
    v_mfma_f32_16x16x32_bf16 v[168:171], v[104:107], v[136:139], v[168:171]
    v_fmac_f32 v49, v33, v81
    v_fmac_f32 v49, v34, v82
    v_fmac_f32 v49, v35, v83
    v_mfma_f32_16x16x32_bf16 v[32:35], v[20:23], v[20:23], 0
    v_fmac_f32 v49, v36, v84
    v_fmac_f32 v49, v37, v85
    v_fmac_f32 v49, v38, v86
    v_fmac_f32 v49, v39, v87
    v_mfma_f32_16x16x32_bf16 v[36:39], a[24:27], v[20:23], 0
    v_fmac_f32 v50, v29, v60
    v_and_b32 v65, 0xffff0000, v65
L_step94:
    s_waitcnt vmcnt(4) lgkmcnt(1)
    v_mfma_f32_16x16x32_bf16 v[140:143], v[92:95], v[108:111], v[140:143]
    s_barrier
    ds_read_b64_tr_b16 v[100:101], v4 offset:0
    s_add_u32 m0, s55, 24576
    s_mov_b32 s56, 770048
    v_mfma_f32_16x16x32_bf16 v[148:151], v[92:95], v[112:115], v[148:151]
    buffer_load_dwordx4 v5, s[28:31], s56 offen  lds
    v_fmac_f32 v50, v32, v88
    v_mfma_f32_16x16x32_bf16 v[152:155], v[96:99], v[112:115], v[152:155]
    ds_read_b128 v[124:127], v1 offset:45408
    v_fmac_f32 v50, v33, v89
    v_mfma_f32_16x16x32_bf16 v[28:31], a[88:91], v[20:23], 0
    ds_read_b64_tr_b16 v[102:103], v4 offset:1024
    v_fmac_f32 v50, v34, v90
    v_mfma_f32_16x16x32_bf16 v[144:147], v[96:99], v[108:111], v[144:147]
    ds_read_b128 v[128:131], v1 offset:46432
    v_fmac_f32 v50, v35, v91
    v_mfma_f32_16x16x32_bf16 v[32:35], a[152:155], v[20:23], 0
    buffer_load_dwordx4 v5, s[28:31], s56 offen offset:1024  lds
    v_fmac_f32 v50, v36, v68
    v_mfma_f32_16x16x32_bf16 v[160:163], v[96:99], v[116:119], v[160:163]
    ds_read_b64_tr_b16 v[104:105], v2 offset:0
    v_fmac_f32 v50, v37, v69
    v_fmac_f32 v50, v38, v70
    v_fmac_f32 v50, v39, v71
    v_mfma_f32_16x16x32_bf16 v[36:39], a[216:219], v[20:23], 0
    ds_read_b128 v[132:135], v1 offset:47456
    v_fmac_f32 v50, v28, v72
    v_mfma_f32_16x16x32_bf16 v[156:159], v[92:95], v[116:119], v[156:159]
    ds_read_b64_tr_b16 v[106:107], v2 offset:1024
    v_fmac_f32 v50, v29, v73
    v_fmac_f32 v50, v30, v74
    v_fmac_f32 v50, v31, v75
    v_mfma_f32_16x16x32_bf16 v[28:31], v[216:219], v[20:23], 0
    ds_read_b128 v[136:139], v1 offset:48480
    v_fmac_f32 v50, v32, v76
    v_mfma_f32_16x16x32_bf16 v[164:167], v[92:95], v[120:123], v[164:167]
    v_fmac_f32 v50, v33, v77
    v_fmac_f32 v50, v34, v78
    v_fmac_f32 v50, v35, v79
    s_waitcnt lgkmcnt(8)
    v_mfma_f32_16x16x32_bf16 v[32:35], v[184:187], v[24:27], 0
    v_xad_u32 v10, v11, 32, v9
    v_fmac_f32 v50, v36, v80
    v_mfma_f32_16x16x32_bf16 v[168:171], v[96:99], v[120:123], v[168:171]
    ds_read_b128 v[20:23], v10 offset:512
    v_fmac_f32 v50, v37, v81
    v_fmac_f32 v50, v38, v82
    v_fmac_f32 v50, v39, v83
    v_mfma_f32_16x16x32_bf16 v[36:39], v[24:27], v[24:27], 0
    v_fmac_f32 v50, v28, v84
    v_fmac_f32 v50, v29, v85
    v_fmac_f32 v50, v30, v86
    v_fmac_f32 v50, v31, v87
    v_mfma_f32_16x16x32_bf16 v[28:31], a[28:31], v[24:27], 0
    v_fmac_f32 v51, v33, v60
    v_bfe_u32 v16, v19, 2, 1
L_step95:
    s_waitcnt vmcnt(4) lgkmcnt(1)
    v_mfma_f32_16x16x32_bf16 v[140:143], v[100:103], v[124:127], v[140:143]
    s_barrier
    ds_read_b64_tr_b16 v[92:93], v4 offset:8192
    s_add_u32 m0, s55, 32768
    s_mov_b32 s56, 778240
    v_mfma_f32_16x16x32_bf16 v[148:151], v[100:103], v[128:131], v[148:151]
    buffer_load_dwordx4 v5, s[28:31], s56 offen  lds
    v_fmac_f32 v51, v36, v88
    v_mfma_f32_16x16x32_bf16 v[152:155], v[104:107], v[128:131], v[152:155]
    ds_read_b128 v[108:111], v0 offset:0
    v_fmac_f32 v51, v37, v89
    v_mfma_f32_16x16x32_bf16 v[32:35], a[92:95], v[24:27], 0
    ds_read_b64_tr_b16 v[94:95], v4 offset:9216
    v_fmac_f32 v51, v38, v90
    v_mfma_f32_16x16x32_bf16 v[144:147], v[104:107], v[124:127], v[144:147]
    ds_read_b128 v[112:115], v0 offset:1024
    v_fmac_f32 v51, v39, v91
    v_mfma_f32_16x16x32_bf16 v[36:39], a[156:159], v[24:27], 0
    buffer_load_dwordx4 v5, s[28:31], s56 offen offset:1024  lds
    v_fmac_f32 v51, v28, v68
    v_mfma_f32_16x16x32_bf16 v[160:163], v[104:107], v[132:135], v[160:163]
    ds_read_b64_tr_b16 v[96:97], v2 offset:8192
    v_fmac_f32 v51, v29, v69
    v_fmac_f32 v51, v30, v70
    v_fmac_f32 v51, v31, v71
    v_mfma_f32_16x16x32_bf16 v[28:31], a[220:223], v[24:27], 0
    ds_read_b128 v[116:119], v0 offset:2048
    v_fmac_f32 v51, v32, v72
    v_mfma_f32_16x16x32_bf16 v[156:159], v[100:103], v[132:135], v[156:159]
    ds_read_b64_tr_b16 v[98:99], v2 offset:9216
    v_fmac_f32 v51, v33, v73
    v_fmac_f32 v51, v34, v74
    v_fmac_f32 v51, v35, v75
    v_mfma_f32_16x16x32_bf16 v[32:35], v[220:223], v[24:27], 0
    ds_read_b128 v[120:123], v0 offset:3072
    v_fmac_f32 v51, v36, v76
    v_fmac_f32 v51, v37, v77
    v_fmac_f32 v51, v38, v78
    v_fmac_f32 v51, v39, v79
    s_waitcnt lgkmcnt(8)
    v_mfma_f32_16x16x32_bf16 v[36:39], v[172:175], v[20:23], 0
    ds_read_b128 v[24:27], v10 offset:576
    v_fmac_f32 v51, v28, v80
    v_mfma_f32_16x16x32_bf16 v[164:167], v[100:103], v[136:139], v[164:167]
    v_fmac_f32 v51, v29, v81
    v_fmac_f32 v51, v30, v82
    v_fmac_f32 v51, v31, v83
    v_mfma_f32_16x16x32_bf16 v[28:31], v[20:23], v[20:23], 0
    v_fmac_f32 v51, v32, v84
    v_fmac_f32 v51, v33, v85
    v_mfma_f32_16x16x32_bf16 v[168:171], v[104:107], v[136:139], v[168:171]
    v_fmac_f32 v51, v34, v86
    v_fmac_f32 v51, v35, v87
    v_mfma_f32_16x16x32_bf16 v[32:35], a[32:35], v[20:23], 0
    v_fmac_f32 v52, v38, v60
    v_bfe_u32 v18, v19, 3, 1
    v_mfma_f32_16x16x32_bf16 v[36:39], a[96:99], v[20:23], 0
    v_fmac_f32 v52, v28, v88
    v_fmac_f32 v52, v29, v89
L_step96:
    s_waitcnt vmcnt(4) lgkmcnt(1)
    v_mfma_f32_16x16x32_bf16 v[140:143], v[92:95], v[108:111], v[140:143]
    s_barrier
    ds_read_b64_tr_b16 v[100:101], v4 offset:16384
    v_mfma_f32_16x16x32_bf16 v[148:151], v[92:95], v[112:115], v[148:151]
    ds_read_b128 v[124:127], v0 offset:4128
    v_fmac_f32 v52, v30, v90
    v_mfma_f32_16x16x32_bf16 v[152:155], v[96:99], v[112:115], v[152:155]
    ds_read_b64_tr_b16 v[102:103], v4 offset:17408
    v_fmac_f32 v52, v31, v91
    v_mfma_f32_16x16x32_bf16 v[28:31], a[160:163], v[20:23], 0
    ds_read_b128 v[128:131], v0 offset:5152
    v_fmac_f32 v52, v32, v68
    v_mfma_f32_16x16x32_bf16 v[144:147], v[96:99], v[108:111], v[144:147]
    ds_read_b64_tr_b16 v[104:105], v2 offset:16384
    v_fmac_f32 v52, v33, v69
    v_fmac_f32 v52, v34, v70
    v_fmac_f32 v52, v35, v71
    v_mfma_f32_16x16x32_bf16 v[32:35], a[224:227], v[20:23], 0
    ds_read_b128 v[132:135], v0 offset:6176
    v_fmac_f32 v52, v36, v72
    v_mfma_f32_16x16x32_bf16 v[160:163], v[96:99], v[116:119], v[160:163]
    ds_read_b64_tr_b16 v[106:107], v2 offset:17408
    v_fmac_f32 v52, v37, v73
    v_fmac_f32 v52, v38, v74
    v_fmac_f32 v52, v39, v75
    v_mfma_f32_16x16x32_bf16 v[36:39], v[224:227], v[20:23], 0
    ds_read_b128 v[136:139], v0 offset:7200
    v_fmac_f32 v52, v28, v76
    v_mfma_f32_16x16x32_bf16 v[156:159], v[92:95], v[116:119], v[156:159]
    v_fmac_f32 v52, v29, v77
    v_fmac_f32 v52, v30, v78
    v_fmac_f32 v52, v31, v79
    s_waitcnt lgkmcnt(8)
    v_mfma_f32_16x16x32_bf16 v[28:31], v[176:179], v[24:27], 0
    ds_read_b128 v[20:23], v10 offset:640
    v_fmac_f32 v52, v32, v80
    v_mfma_f32_16x16x32_bf16 v[164:167], v[92:95], v[120:123], v[164:167]
    v_fmac_f32 v52, v33, v81
    v_fmac_f32 v52, v34, v82
    v_fmac_f32 v52, v35, v83
    v_mfma_f32_16x16x32_bf16 v[32:35], v[24:27], v[24:27], 0
    v_fmac_f32 v52, v36, v84
    v_fmac_f32 v52, v37, v85
    v_mfma_f32_16x16x32_bf16 v[168:171], v[96:99], v[120:123], v[168:171]
    v_fmac_f32 v52, v38, v86
    v_fmac_f32 v52, v39, v87
    v_mfma_f32_16x16x32_bf16 v[36:39], a[36:39], v[24:27], 0
    v_fmac_f32 v53, v30, v60
    v_lshl_or_b32 v16, v16, 1, v18
    v_mfma_f32_16x16x32_bf16 v[28:31], a[100:103], v[24:27], 0
    v_fmac_f32 v53, v32, v88
    v_fmac_f32 v53, v33, v89
L_step97:
    s_waitcnt vmcnt(2) lgkmcnt(1)
    v_mfma_f32_16x16x32_bf16 v[140:143], v[100:103], v[124:127], v[140:143]
    s_barrier
    ds_read_b64_tr_b16 v[92:93], v4 offset:24576
    v_mfma_f32_16x16x32_bf16 v[148:151], v[100:103], v[128:131], v[148:151]
    ds_read_b128 v[108:111], v0 offset:8256
    v_fmac_f32 v53, v34, v90
    v_mfma_f32_16x16x32_bf16 v[152:155], v[104:107], v[128:131], v[152:155]
    ds_read_b64_tr_b16 v[94:95], v4 offset:25600
    v_fmac_f32 v53, v35, v91
    v_mfma_f32_16x16x32_bf16 v[32:35], a[164:167], v[24:27], 0
    ds_read_b128 v[112:115], v0 offset:9280
    v_fmac_f32 v53, v36, v68
    v_mfma_f32_16x16x32_bf16 v[144:147], v[104:107], v[124:127], v[144:147]
    ds_read_b64_tr_b16 v[96:97], v2 offset:24576
    v_fmac_f32 v53, v37, v69
    v_fmac_f32 v53, v38, v70
    v_fmac_f32 v53, v39, v71
    v_mfma_f32_16x16x32_bf16 v[36:39], a[228:231], v[24:27], 0
    ds_read_b128 v[116:119], v0 offset:10304
    v_fmac_f32 v53, v28, v72
    v_mfma_f32_16x16x32_bf16 v[160:163], v[104:107], v[132:135], v[160:163]
    ds_read_b64_tr_b16 v[98:99], v2 offset:25600
    v_fmac_f32 v53, v29, v73
    v_fmac_f32 v53, v30, v74
    v_fmac_f32 v53, v31, v75
    v_mfma_f32_16x16x32_bf16 v[28:31], v[228:231], v[24:27], 0
    ds_read_b128 v[120:123], v0 offset:11328
    v_fmac_f32 v53, v32, v76
    v_mfma_f32_16x16x32_bf16 v[156:159], v[100:103], v[132:135], v[156:159]
    v_fmac_f32 v53, v33, v77
    v_fmac_f32 v53, v34, v78
    v_fmac_f32 v53, v35, v79
    s_waitcnt lgkmcnt(8)
    v_mfma_f32_16x16x32_bf16 v[32:35], v[180:183], v[20:23], 0
    ds_read_b128 v[24:27], v10 offset:704
    v_fmac_f32 v53, v36, v80
    v_fmac_f32 v53, v37, v81
    v_fmac_f32 v53, v38, v82
    v_fmac_f32 v53, v39, v83
    v_mfma_f32_16x16x32_bf16 v[36:39], v[20:23], v[20:23], 0
    v_fmac_f32 v53, v28, v84
    v_fmac_f32 v53, v29, v85
    v_mfma_f32_16x16x32_bf16 v[164:167], v[100:103], v[136:139], v[164:167]
    v_fmac_f32 v53, v30, v86
    v_fmac_f32 v53, v31, v87
    v_mfma_f32_16x16x32_bf16 v[28:31], a[40:43], v[20:23], 0
    v_fmac_f32 v54, v34, v60
    v_lshl_add_u32 v16, v16, 2, v11
    v_mfma_f32_16x16x32_bf16 v[168:171], v[104:107], v[136:139], v[168:171]
    v_fmac_f32 v54, v36, v88
    v_fmac_f32 v54, v37, v89
    v_mfma_f32_16x16x32_bf16 v[32:35], a[104:107], v[20:23], 0
    v_fmac_f32 v54, v38, v90
    v_fmac_f32 v54, v39, v91
    v_mfma_f32_16x16x32_bf16 v[36:39], a[168:171], v[20:23], 0
    v_fmac_f32 v54, v28, v68
    v_fmac_f32 v54, v29, v69
L_step98:
    s_waitcnt vmcnt(0) lgkmcnt(1)
    v_mfma_f32_16x16x32_bf16 v[140:143], v[92:95], v[108:111], v[140:143]
    s_barrier
    ds_read_b64_tr_b16 v[100:101], v4 offset:32768
    v_mfma_f32_16x16x32_bf16 v[148:151], v[92:95], v[112:115], v[148:151]
    ds_read_b128 v[124:127], v0 offset:12384
    v_fmac_f32 v54, v30, v70
    v_mfma_f32_16x16x32_bf16 v[152:155], v[96:99], v[112:115], v[152:155]
    ds_read_b64_tr_b16 v[102:103], v4 offset:33792
    v_fmac_f32 v54, v31, v71
    v_mfma_f32_16x16x32_bf16 v[28:31], a[232:235], v[20:23], 0
    ds_read_b128 v[128:131], v0 offset:13408
    v_fmac_f32 v54, v32, v72
    v_mfma_f32_16x16x32_bf16 v[144:147], v[96:99], v[108:111], v[144:147]
    ds_read_b64_tr_b16 v[104:105], v2 offset:32768
    v_fmac_f32 v54, v33, v73
    v_fmac_f32 v54, v34, v74
    v_fmac_f32 v54, v35, v75
    v_mfma_f32_16x16x32_bf16 v[32:35], v[232:235], v[20:23], 0
    ds_read_b128 v[132:135], v0 offset:14432
    v_fmac_f32 v54, v36, v76
    v_mfma_f32_16x16x32_bf16 v[160:163], v[96:99], v[116:119], v[160:163]
    ds_read_b64_tr_b16 v[106:107], v2 offset:33792
    v_fmac_f32 v54, v37, v77
    v_fmac_f32 v54, v38, v78
    v_fmac_f32 v54, v39, v79
    s_waitcnt lgkmcnt(7)
    v_mfma_f32_16x16x32_bf16 v[36:39], v[184:187], v[24:27], 0
    ds_read_b128 v[136:139], v0 offset:15456
    v_xad_u32 v10, v11, 16, v9
    v_mfma_f32_16x16x32_bf16 v[156:159], v[92:95], v[116:119], v[156:159]
    ds_read_b128 v[20:23], v10 offset:768
    v_fmac_f32 v54, v28, v80
    v_fmac_f32 v54, v29, v81
    v_fmac_f32 v54, v30, v82
    v_fmac_f32 v54, v31, v83
    v_mfma_f32_16x16x32_bf16 v[28:31], v[24:27], v[24:27], 0
    v_fmac_f32 v54, v32, v84
    v_fmac_f32 v54, v33, v85
    v_mfma_f32_16x16x32_bf16 v[164:167], v[92:95], v[120:123], v[164:167]
    v_fmac_f32 v54, v34, v86
    v_fmac_f32 v54, v35, v87
    v_mfma_f32_16x16x32_bf16 v[32:35], a[44:47], v[24:27], 0
    v_fmac_f32 v55, v38, v60
    s_add_u32 s59, s57, 141056
    v_mfma_f32_16x16x32_bf16 v[168:171], v[96:99], v[120:123], v[168:171]
    v_fmac_f32 v55, v28, v88
    v_fmac_f32 v55, v29, v89
    v_mfma_f32_16x16x32_bf16 v[36:39], a[108:111], v[24:27], 0
    v_fmac_f32 v55, v30, v90
    v_fmac_f32 v55, v31, v91
    v_mfma_f32_16x16x32_bf16 v[28:31], a[172:175], v[24:27], 0
    v_fmac_f32 v55, v32, v68
    v_fmac_f32 v55, v33, v69
L_step99:
    s_waitcnt lgkmcnt(1)
    v_mfma_f32_16x16x32_bf16 v[140:143], v[100:103], v[124:127], v[140:143]
    s_barrier
    v_fmac_f32 v55, v34, v70
    v_mfma_f32_16x16x32_bf16 v[148:151], v[100:103], v[128:131], v[148:151]
    v_fmac_f32 v55, v35, v71
    v_fmac_f32 v55, v36, v72
    v_mfma_f32_16x16x32_bf16 v[152:155], v[104:107], v[128:131], v[152:155]
    v_fmac_f32 v55, v37, v73
    v_fmac_f32 v55, v38, v74
    v_mfma_f32_16x16x32_bf16 v[32:35], a[236:239], v[24:27], 0
    v_fmac_f32 v55, v39, v75
    v_fmac_f32 v55, v28, v76
    v_mfma_f32_16x16x32_bf16 v[144:147], v[104:107], v[124:127], v[144:147]
    v_fmac_f32 v55, v29, v77
    v_fmac_f32 v55, v30, v78
    v_mfma_f32_16x16x32_bf16 v[36:39], v[236:239], v[24:27], 0
    v_fmac_f32 v55, v31, v79
    v_add_u32 v16, s59, v16
    v_mfma_f32_16x16x32_bf16 v[160:163], v[104:107], v[132:135], v[160:163]
    v_fmac_f32 v55, v32, v80
    v_fmac_f32 v55, v33, v81
    s_waitcnt lgkmcnt(0)
    v_mfma_f32_16x16x32_bf16 v[28:31], v[172:175], v[20:23], 0
    ds_read_b128 v[24:27], v10 offset:832
    v_fmac_f32 v55, v34, v82
    v_mfma_f32_16x16x32_bf16 v[156:159], v[100:103], v[132:135], v[156:159]
    v_fmac_f32 v55, v35, v83
    v_fmac_f32 v55, v36, v84
    v_mfma_f32_16x16x32_bf16 v[32:35], v[20:23], v[20:23], 0
    v_fmac_f32 v55, v37, v85
    v_fmac_f32 v55, v38, v86
    v_fmac_f32 v55, v39, v87
    v_mfma_f32_16x16x32_bf16 v[36:39], a[48:51], v[20:23], 0
    v_fmac_f32 v56, v31, v60
    s_lshl_b32 s57, s52, 8
    v_mfma_f32_16x16x32_bf16 v[164:167], v[100:103], v[136:139], v[164:167]
    s_add_u32 s57, s57, 140032
    v_fmac_f32 v56, v32, v88
    v_mfma_f32_16x16x32_bf16 v[28:31], a[112:115], v[20:23], 0
    v_fmac_f32 v56, v33, v89
    v_fmac_f32 v56, v34, v90
    v_mfma_f32_16x16x32_bf16 v[168:171], v[104:107], v[136:139], v[168:171]
    v_fmac_f32 v56, v35, v91
    v_fmac_f32 v56, v36, v68
    v_mfma_f32_16x16x32_bf16 v[32:35], a[176:179], v[20:23], 0
    v_fmac_f32 v56, v37, v69
    v_fmac_f32 v56, v38, v70
    v_fmac_f32 v56, v39, v71
    v_mfma_f32_16x16x32_bf16 v[36:39], a[240:243], v[20:23], 0
    v_fmac_f32 v56, v28, v72
    v_fmac_f32 v56, v29, v73
    v_fmac_f32 v56, v30, v74
    v_fmac_f32 v56, v31, v75
    v_mfma_f32_16x16x32_bf16 v[28:31], v[240:243], v[20:23], 0
    v_fmac_f32 v56, v32, v76
    v_fmac_f32 v56, v33, v77
    v_fmac_f32 v56, v34, v78
    v_fmac_f32 v56, v35, v79
    s_waitcnt lgkmcnt(0)
    v_mfma_f32_16x16x32_bf16 v[32:35], v[176:179], v[24:27], 0
    ds_read_b128 v[20:23], v10 offset:896
    v_fmac_f32 v56, v36, v80
    v_fmac_f32 v56, v37, v81
    v_fmac_f32 v56, v38, v82
    v_fmac_f32 v56, v39, v83
    v_mfma_f32_16x16x32_bf16 v[36:39], v[24:27], v[24:27], 0
    v_fmac_f32 v56, v28, v84
    v_fmac_f32 v56, v29, v85
    v_fmac_f32 v56, v30, v86
    v_fmac_f32 v56, v31, v87
    v_mfma_f32_16x16x32_bf16 v[28:31], a[52:55], v[24:27], 0
    v_fmac_f32 v57, v35, v60
    v_lshl_add_u32 v18, v19, 2, s57
    v_mfma_f32_16x16x32_bf16 v[32:35], a[116:119], v[24:27], 0
    v_fmac_f32 v57, v36, v88
    v_fmac_f32 v57, v37, v89
    v_fmac_f32 v57, v38, v90
    v_fmac_f32 v57, v39, v91
    v_mfma_f32_16x16x32_bf16 v[36:39], a[180:183], v[24:27], 0
    v_fmac_f32 v57, v28, v68
    v_fmac_f32 v57, v29, v69
    v_fmac_f32 v57, v30, v70
    v_fmac_f32 v57, v31, v71
    v_mfma_f32_16x16x32_bf16 v[28:31], a[244:247], v[24:27], 0
    v_fmac_f32 v57, v32, v72
    v_fmac_f32 v57, v33, v73
    v_fmac_f32 v57, v34, v74
    v_fmac_f32 v57, v35, v75
    v_mfma_f32_16x16x32_bf16 v[32:35], v[244:247], v[24:27], 0
    v_fmac_f32 v57, v36, v76
    v_fmac_f32 v57, v37, v77
    v_fmac_f32 v57, v38, v78
    v_fmac_f32 v57, v39, v79
    s_waitcnt lgkmcnt(0)
    v_mfma_f32_16x16x32_bf16 v[36:39], v[180:183], v[20:23], 0
    ds_read_b128 v[24:27], v10 offset:960
    v_fmac_f32 v57, v28, v80
    v_fmac_f32 v57, v29, v81
    v_fmac_f32 v57, v30, v82
    v_fmac_f32 v57, v31, v83
    v_mfma_f32_16x16x32_bf16 v[28:31], v[20:23], v[20:23], 0
    v_fmac_f32 v57, v32, v84
    v_fmac_f32 v57, v33, v85
    v_fmac_f32 v57, v34, v86
    v_fmac_f32 v57, v35, v87
    v_mfma_f32_16x16x32_bf16 v[32:35], a[56:59], v[20:23], 0
    v_fmac_f32 v58, v39, v60
    v_mov_b32 v14, 0xc0135761
    v_mfma_f32_16x16x32_bf16 v[36:39], a[120:123], v[20:23], 0
    v_fmac_f32 v58, v28, v88
    v_fmac_f32 v58, v29, v89
    v_fmac_f32 v58, v30, v90
    v_fmac_f32 v58, v31, v91
    v_mfma_f32_16x16x32_bf16 v[28:31], a[184:187], v[20:23], 0
    v_fmac_f32 v58, v32, v68
    v_fmac_f32 v58, v33, v69
    v_fmac_f32 v58, v34, v70
    v_fmac_f32 v58, v35, v71
    v_mfma_f32_16x16x32_bf16 v[32:35], a[248:251], v[20:23], 0
    v_fmac_f32 v58, v36, v72
    v_fmac_f32 v58, v37, v73
    v_fmac_f32 v58, v38, v74
    v_fmac_f32 v58, v39, v75
    v_mfma_f32_16x16x32_bf16 v[36:39], v[248:251], v[20:23], 0
    v_fmac_f32 v58, v28, v76
    v_fmac_f32 v58, v29, v77
    v_fmac_f32 v58, v30, v78
    v_fmac_f32 v58, v31, v79
    s_waitcnt lgkmcnt(0)
    v_mfma_f32_16x16x32_bf16 v[28:31], v[184:187], v[24:27], 0
    v_fmac_f32 v58, v32, v80
    v_fmac_f32 v58, v33, v81
    v_fmac_f32 v58, v34, v82
    v_fmac_f32 v58, v35, v83
    v_mfma_f32_16x16x32_bf16 v[32:35], v[24:27], v[24:27], 0
    v_fmac_f32 v58, v36, v84
    v_fmac_f32 v58, v37, v85
    v_fmac_f32 v58, v38, v86
    v_fmac_f32 v58, v39, v87
    v_mfma_f32_16x16x32_bf16 v[36:39], a[60:63], v[24:27], 0
    v_fmac_f32 v59, v31, v60
    s_mov_b32 s98, 0xbdd2d3e8
    v_mfma_f32_16x16x32_bf16 v[28:31], a[124:127], v[24:27], 0
    v_fmac_f32 v59, v32, v88
    v_fmac_f32 v59, v33, v89
    v_fmac_f32 v59, v34, v90
    v_fmac_f32 v59, v35, v91
    v_mfma_f32_16x16x32_bf16 v[32:35], a[188:191], v[24:27], 0
    v_fmac_f32 v59, v36, v68
    v_fmac_f32 v59, v37, v69
    v_fmac_f32 v59, v38, v70
    v_fmac_f32 v59, v39, v71
    v_mfma_f32_16x16x32_bf16 v[36:39], a[252:255], v[24:27], 0
    v_fmac_f32 v59, v28, v72
    v_fmac_f32 v59, v29, v73
    v_fmac_f32 v59, v30, v74
    v_fmac_f32 v59, v31, v75
    v_mfma_f32_16x16x32_bf16 v[28:31], v[252:255], v[24:27], 0
    v_fmac_f32 v59, v32, v76
    v_fmac_f32 v59, v33, v77
    v_fmac_f32 v59, v34, v78
    v_fmac_f32 v59, v35, v79
    v_fmac_f32 v59, v36, v80
    v_fmac_f32 v59, v37, v81
    v_fmac_f32 v59, v38, v82
    v_fmac_f32 v59, v39, v83
    v_fmac_f32 v59, v28, v84
    v_fmac_f32 v59, v29, v85
    v_fmac_f32 v59, v30, v86
    v_fmac_f32 v59, v31, v87
    s_lshl_b32 s58, s58, 16
    v_permlane32_swap_b32 v44, v52
    v_permlane32_swap_b32 v45, v53
    v_permlane32_swap_b32 v46, v54
    v_permlane32_swap_b32 v47, v55
    v_permlane32_swap_b32 v48, v56
    v_permlane32_swap_b32 v49, v57
    v_permlane32_swap_b32 v50, v58
    v_permlane32_swap_b32 v51, v59
    v_add_f32 v44, v44, v52
    v_add_f32 v45, v45, v53
    v_add_f32 v46, v46, v54
    v_add_f32 v47, v47, v55
    v_add_f32 v48, v48, v56
    v_add_f32 v49, v49, v57
    v_add_f32 v50, v50, v58
    v_add_f32 v51, v51, v59
    v_permlane16_swap_b32 v44, v48
    v_permlane16_swap_b32 v45, v49
    v_permlane16_swap_b32 v46, v50
    v_permlane16_swap_b32 v47, v51
    v_add_f32 v44, v44, v48
    v_add_f32 v45, v45, v49
    v_add_f32 v46, v46, v50
    v_add_f32 v47, v47, v51
    s_lshl_b32 s57, s2, 7
.p2align 3
    v_add_f32_dpp v44, v44, v44 row_ror:8 row_mask:0xf bank_mask:0x3
    v_pk_mul_f32 v[124:125], v[140:141], v[140:141]
    v_pk_mul_f32 v[126:127], v[142:143], v[142:143]
    v_pk_mul_f32 v[128:129], v[144:145], v[144:145]
    v_pk_mul_f32 v[130:131], v[146:147], v[146:147]
    v_pk_fma_f32 v[124:125], v[124:125], s[98:99], v[14:15] op_sel_hi:[1,0,0]
    v_pk_fma_f32 v[126:127], v[126:127], s[98:99], v[14:15] op_sel_hi:[1,0,0]
    v_pk_fma_f32 v[128:129], v[128:129], s[98:99], v[14:15] op_sel_hi:[1,0,0]
    v_pk_fma_f32 v[130:131], v[130:131], s[98:99], v[14:15] op_sel_hi:[1,0,0]
    v_add_f32_dpp v46, v46, v46 row_ror:8 row_mask:0xf bank_mask:0x3
    v_pk_mul_f32 v[124:125], v[124:125], v[140:141]
    v_pk_mul_f32 v[126:127], v[126:127], v[142:143]
    v_pk_mul_f32 v[128:129], v[128:129], v[144:145]
    v_pk_mul_f32 v[130:131], v[130:131], v[146:147]
    v_exp_f32 v124, v124
    v_exp_f32 v125, v125
    v_exp_f32 v126, v126
    v_exp_f32 v127, v127
    v_exp_f32 v128, v128
    v_exp_f32 v129, v129
    v_exp_f32 v130, v130
    v_exp_f32 v131, v131
    v_add_f32_dpp v44, v45, v45 row_ror:8 row_mask:0xf bank_mask:0xc
    v_pk_mul_f32 v[140:141], v[140:141], v[40:41]
    v_pk_mul_f32 v[142:143], v[142:143], v[42:43]
    v_pk_mul_f32 v[144:145], v[144:145], v[62:63]
    v_pk_mul_f32 v[146:147], v[146:147], v[64:65]
    v_pk_add_f32 v[124:125], v[124:125], 1.0 op_sel_hi:[1,0]
    v_pk_add_f32 v[126:127], v[126:127], 1.0 op_sel_hi:[1,0]
    v_pk_add_f32 v[128:129], v[128:129], 1.0 op_sel_hi:[1,0]
    v_pk_add_f32 v[130:131], v[130:131], 1.0 op_sel_hi:[1,0]
    v_rcp_f32 v124, v124
    v_rcp_f32 v125, v125
    v_rcp_f32 v126, v126
    v_rcp_f32 v127, v127
    v_rcp_f32 v128, v128
    v_rcp_f32 v129, v129
    v_rcp_f32 v130, v130
    v_rcp_f32 v131, v131
    v_pk_mul_f32 v[52:53], v[140:141], v[124:125]
    v_pk_fma_f32 v[52:53], v[142:143], v[126:127], v[52:53]
    v_pk_mul_f32 v[28:29], v[144:145], v[128:129]
    v_pk_fma_f32 v[28:29], v[146:147], v[130:131], v[28:29]
    v_add_f32_dpp v46, v47, v47 row_ror:8 row_mask:0xf bank_mask:0xc
    v_pk_mul_f32 v[124:125], v[148:149], v[148:149]
    v_pk_mul_f32 v[126:127], v[150:151], v[150:151]
    v_pk_mul_f32 v[128:129], v[152:153], v[152:153]
    v_pk_mul_f32 v[130:131], v[154:155], v[154:155]
    v_pk_fma_f32 v[124:125], v[124:125], s[98:99], v[14:15] op_sel_hi:[1,0,0]
    v_pk_fma_f32 v[126:127], v[126:127], s[98:99], v[14:15] op_sel_hi:[1,0,0]
    v_pk_fma_f32 v[128:129], v[128:129], s[98:99], v[14:15] op_sel_hi:[1,0,0]
    v_pk_fma_f32 v[130:131], v[130:131], s[98:99], v[14:15] op_sel_hi:[1,0,0]
    v_add_f32_dpp v44, v44, v44 row_shl:4 row_mask:0xf bank_mask:0x5
    v_pk_mul_f32 v[124:125], v[124:125], v[148:149]
    v_pk_mul_f32 v[126:127], v[126:127], v[150:151]
    v_pk_mul_f32 v[128:129], v[128:129], v[152:153]
    v_pk_mul_f32 v[130:131], v[130:131], v[154:155]
    v_exp_f32 v124, v124
    v_exp_f32 v125, v125
    v_exp_f32 v126, v126
    v_exp_f32 v127, v127
    v_exp_f32 v128, v128
    v_exp_f32 v129, v129
    v_exp_f32 v130, v130
    v_exp_f32 v131, v131
    v_add_f32_dpp v44, v46, v46 row_shr:4 row_mask:0xf bank_mask:0xa
    v_pk_mul_f32 v[148:149], v[148:149], v[40:41]
    v_pk_mul_f32 v[150:151], v[150:151], v[42:43]
    v_pk_mul_f32 v[152:153], v[152:153], v[62:63]
    v_pk_mul_f32 v[154:155], v[154:155], v[64:65]
    v_pk_add_f32 v[124:125], v[124:125], 1.0 op_sel_hi:[1,0]
    v_pk_add_f32 v[126:127], v[126:127], 1.0 op_sel_hi:[1,0]
    v_pk_add_f32 v[128:129], v[128:129], 1.0 op_sel_hi:[1,0]
    v_pk_add_f32 v[130:131], v[130:131], 1.0 op_sel_hi:[1,0]
    v_rcp_f32 v124, v124
    v_rcp_f32 v125, v125
    v_rcp_f32 v126, v126
    v_rcp_f32 v127, v127
    v_rcp_f32 v128, v128
    v_rcp_f32 v129, v129
    v_rcp_f32 v130, v130
    v_rcp_f32 v131, v131
    v_pk_mul_f32 v[54:55], v[148:149], v[124:125]
    v_pk_fma_f32 v[54:55], v[150:151], v[126:127], v[54:55]
    v_pk_mul_f32 v[30:31], v[152:153], v[128:129]
    v_pk_fma_f32 v[30:31], v[154:155], v[130:131], v[30:31]
    v_add_f32_dpp v44, v44, v44 quad_perm:[2,3,0,1] row_mask:0xf bank_mask:0xf
    v_pk_mul_f32 v[124:125], v[156:157], v[156:157]
    v_pk_mul_f32 v[126:127], v[158:159], v[158:159]
    v_pk_mul_f32 v[128:129], v[160:161], v[160:161]
    v_pk_mul_f32 v[130:131], v[162:163], v[162:163]
    v_pk_fma_f32 v[124:125], v[124:125], s[98:99], v[14:15] op_sel_hi:[1,0,0]
    v_pk_fma_f32 v[126:127], v[126:127], s[98:99], v[14:15] op_sel_hi:[1,0,0]
    v_pk_fma_f32 v[128:129], v[128:129], s[98:99], v[14:15] op_sel_hi:[1,0,0]
    v_pk_fma_f32 v[130:131], v[130:131], s[98:99], v[14:15] op_sel_hi:[1,0,0]
    v_add_f32_dpp v44, v44, v44 quad_perm:[1,0,3,2] row_mask:0xf bank_mask:0xf
    v_pk_mul_f32 v[124:125], v[124:125], v[156:157]
    v_pk_mul_f32 v[126:127], v[126:127], v[158:159]
    v_pk_mul_f32 v[128:129], v[128:129], v[160:161]
    v_pk_mul_f32 v[130:131], v[130:131], v[162:163]
    v_exp_f32 v124, v124
    v_exp_f32 v125, v125
    v_exp_f32 v126, v126
    v_exp_f32 v127, v127
    v_exp_f32 v128, v128
    v_exp_f32 v129, v129
    v_exp_f32 v130, v130
    v_exp_f32 v131, v131
    ds_write_b32 v16, v44
    v_pk_mul_f32 v[156:157], v[156:157], v[40:41]
    v_pk_mul_f32 v[158:159], v[158:159], v[42:43]
    v_pk_mul_f32 v[160:161], v[160:161], v[62:63]
    v_pk_mul_f32 v[162:163], v[162:163], v[64:65]
    v_pk_add_f32 v[124:125], v[124:125], 1.0 op_sel_hi:[1,0]
    v_pk_add_f32 v[126:127], v[126:127], 1.0 op_sel_hi:[1,0]
    v_pk_add_f32 v[128:129], v[128:129], 1.0 op_sel_hi:[1,0]
    v_pk_add_f32 v[130:131], v[130:131], 1.0 op_sel_hi:[1,0]
    v_rcp_f32 v124, v124
    v_rcp_f32 v125, v125
    v_rcp_f32 v126, v126
    v_rcp_f32 v127, v127
    v_rcp_f32 v128, v128
    v_rcp_f32 v129, v129
    v_rcp_f32 v130, v130
    v_rcp_f32 v131, v131
    v_pk_mul_f32 v[56:57], v[156:157], v[124:125]
    v_pk_fma_f32 v[56:57], v[158:159], v[126:127], v[56:57]
    v_pk_mul_f32 v[32:33], v[160:161], v[128:129]
    v_pk_fma_f32 v[32:33], v[162:163], v[130:131], v[32:33]
    v_pk_mul_f32 v[124:125], v[164:165], v[164:165]
    v_pk_mul_f32 v[126:127], v[166:167], v[166:167]
    v_pk_mul_f32 v[128:129], v[168:169], v[168:169]
    v_pk_mul_f32 v[130:131], v[170:171], v[170:171]
    v_pk_fma_f32 v[124:125], v[124:125], s[98:99], v[14:15] op_sel_hi:[1,0,0]
    v_pk_fma_f32 v[126:127], v[126:127], s[98:99], v[14:15] op_sel_hi:[1,0,0]
    v_pk_fma_f32 v[128:129], v[128:129], s[98:99], v[14:15] op_sel_hi:[1,0,0]
    v_pk_fma_f32 v[130:131], v[130:131], s[98:99], v[14:15] op_sel_hi:[1,0,0]
    v_pk_mul_f32 v[124:125], v[124:125], v[164:165]
    v_pk_mul_f32 v[126:127], v[126:127], v[166:167]
    v_pk_mul_f32 v[128:129], v[128:129], v[168:169]
    v_pk_mul_f32 v[130:131], v[130:131], v[170:171]
    v_exp_f32 v124, v124
    v_exp_f32 v125, v125
    v_exp_f32 v126, v126
    v_exp_f32 v127, v127
    v_exp_f32 v128, v128
    v_exp_f32 v129, v129
    v_exp_f32 v130, v130
    v_exp_f32 v131, v131
    v_pk_mul_f32 v[164:165], v[164:165], v[40:41]
    v_pk_mul_f32 v[166:167], v[166:167], v[42:43]
    v_pk_mul_f32 v[168:169], v[168:169], v[62:63]
    v_pk_mul_f32 v[170:171], v[170:171], v[64:65]
    v_pk_add_f32 v[124:125], v[124:125], 1.0 op_sel_hi:[1,0]
    v_pk_add_f32 v[126:127], v[126:127], 1.0 op_sel_hi:[1,0]
    v_pk_add_f32 v[128:129], v[128:129], 1.0 op_sel_hi:[1,0]
    v_pk_add_f32 v[130:131], v[130:131], 1.0 op_sel_hi:[1,0]
    v_rcp_f32 v124, v124
    v_rcp_f32 v125, v125
    v_rcp_f32 v126, v126
    v_rcp_f32 v127, v127
    v_rcp_f32 v128, v128
    v_rcp_f32 v129, v129
    v_rcp_f32 v130, v130
    v_rcp_f32 v131, v131
    v_pk_mul_f32 v[58:59], v[164:165], v[124:125]
    v_pk_fma_f32 v[58:59], v[166:167], v[126:127], v[58:59]
    v_pk_mul_f32 v[34:35], v[168:169], v[128:129]
    v_pk_fma_f32 v[34:35], v[170:171], v[130:131], v[34:35]
    v_pk_add_f32 v[52:53], v[52:53], v[28:29]
    v_pk_add_f32 v[54:55], v[54:55], v[30:31]
    v_pk_add_f32 v[56:57], v[56:57], v[32:33]
    v_pk_add_f32 v[58:59], v[58:59], v[34:35]
    v_add_f32 v52, v52, v53
    v_add_f32 v54, v54, v55
    v_add_f32 v56, v56, v57
    v_add_f32 v58, v58, v59
    s_nop 0
    v_permlane32_swap_b32 v52, v56
    v_permlane32_swap_b32 v54, v58
    v_add_f32 v52, v52, v56
    v_add_f32 v54, v54, v58
    s_nop 1
    v_permlane16_swap_b32 v52, v54
    v_add_f32 v52, v52, v54
    ds_write_b32 v18, v52
    s_waitcnt lgkmcnt(0)
    s_barrier
    s_cmp_lg_u32 s52, 0
    s_cbranch_scc1 L_fin
    ds_read_b32 v124, v18 offset:0
    ds_read_b32 v125, v18 offset:256
    ds_read_b32 v126, v18 offset:512
    ds_read_b32 v127, v18 offset:768
    ds_read_b32 v128, v18 offset:1024
    s_waitcnt lgkmcnt(0)
    v_add_f32 v124, v124, v125
    v_add_f32 v126, v126, v127
    v_add_f32 v128, s58, v128
    v_add_f32 v124, v124, v126
    v_add_f32 v124, v124, v128
    v_cvt_pk_bf16_f32 v124, v124, v124
    buffer_store_short v124, v15, s[44:47], s57 offen
L_fin:
L_end:
    s_endpgm
.section .rodata,"a"
.p2align 6
.amdhsa_kernel standalone__deep_cross_pnn__recsys_kernel
  .amdhsa_next_free_vgpr 512
  .amdhsa_next_free_sgpr 102
  .amdhsa_accum_offset 256
  .amdhsa_group_segment_fixed_size 0
  .amdhsa_kernarg_size 80
  .amdhsa_user_sgpr_count 2
  .amdhsa_user_sgpr_kernarg_segment_ptr 1
  .amdhsa_system_sgpr_workgroup_id_x 1
  .amdhsa_float_denorm_mode_32 3
.end_amdhsa_kernel
```
